```python
import torch

def _softmax(x, axis=-1):
    return torch.softmax(x, dim=axis)

def _gelu(x):
    return torch.nn.functional.gelu(x, approximate='tanh')

def _silu(x):
    return torch.nn.functional.silu(x)

def _sigmoid(x):
    return torch.sigmoid(x)

def _layernorm(x, axis=-1, eps=1e-05):
    m = x.mean(dim=axis, keepdim=True)
    v = x.var(dim=axis, keepdim=True, unbiased=False)
    return (x - m) / torch.sqrt(v + eps)

def _scatter_add(tgt, idx, src, axis=0):
    return tgt.clone().index_add_(axis, idx, src)

def _segment_sum(src, seg, n):
    out = torch.zeros((n,) + src.shape[1:], dtype=src.dtype)
    return out.index_add_(0, seg, src)

def _pad(x, pw):
    flat = tuple((v for pair in reversed(pw) for v in pair))
    return torch.nn.functional.pad(x, flat)
kernel_name = 'adaLN_cond__ssm_conv_s4d__glu_gated_geglu__prompt'

def setup_inputs():

    _w = lambda a: (lambda t: t.to(torch.bfloat16) if t.is_floating_point() else t)(torch.as_tensor(a))

    def _A_setup():
        Bsz, L, D, N = (1, 2048, 512, 128)
        return {'u': _w((lambda *s: torch.randn(*s, dtype=torch.bfloat16) * 0.05)(Bsz, L, D)), 'log_A_real': _w((lambda *s: torch.randn(*s, dtype=torch.bfloat16) * 3.2)(D, N) * 0.5), 'A_imag': _w((lambda *s: torch.randn(*s, dtype=torch.bfloat16) * 0.05)(D, N) * 3.14), 'C_real': _w((lambda *s: torch.randn(*s, dtype=torch.bfloat16) * 0.4)(D, N) / N ** 0.5), 'C_imag': _w((lambda *s: torch.randn(*s, dtype=torch.bfloat16) * 0.4)(D, N) / N ** 0.5), 'log_dt': _w((lambda *s: torch.randn(*s, dtype=torch.bfloat16) * 0.05)(D) * 0.5 - 4.0), 'D_skip': _w((lambda *s: torch.randn(*s, dtype=torch.bfloat16) * 0.1)(D))}
    _A_in = _A_setup()

    def _B_setup():
        B, S, Dm, Df = (1, 2048, 512, 1376)
        return {'x': _w((lambda *s: torch.randn(*s, dtype=torch.bfloat16) * 0.05)(B, S, Dm)), 'w_gate': _w((lambda *s: torch.randn(*s, dtype=torch.bfloat16) * 0.8)(Dm, Df) * Dm ** (-0.5)), 'w_up': _w((lambda *s: torch.randn(*s, dtype=torch.bfloat16) * 0.8)(Dm, Df) * Dm ** (-0.5)), 'w_down': _w((lambda *s: torch.randn(*s, dtype=torch.bfloat16) * 0.8)(Df, Dm) * Df ** (-0.5))}
    _B_in = _B_setup()
    return {'A_u': _A_in['u'], 'A_log_A_real': _A_in['log_A_real'], 'A_A_imag': _A_in['A_imag'], 'A_C_real': _A_in['C_real'], 'A_C_imag': _A_in['C_imag'], 'A_log_dt': _A_in['log_dt'], 'A_D_skip': _A_in['D_skip'], 'B_x': _B_in['x'], 'B_w_gate': _B_in['w_gate'], 'B_w_up': _B_in['w_up'], 'B_w_down': _B_in['w_down'], 'c': _w((lambda *s: torch.randn(*s, dtype=torch.bfloat16) * 0.2)(1, 512) * 8.0), 'w_mod': _w((lambda *s: torch.randn(*s, dtype=torch.bfloat16) * 0.2)(512, 6 * 512) * 512 ** (-0.5) * 8.0)}

def reference(A_u, A_log_A_real, A_A_imag, A_C_real, A_C_imag, A_log_dt, A_D_skip, B_x, B_w_gate, B_w_up, B_w_down, c, w_mod):

    def _A_ref(u, log_A_real, A_imag, C_real, C_imag, log_dt, D_skip):
        L = u.shape[1]
        dt = torch.exp(log_dt)
        A = -torch.exp(log_A_real) + 1j * A_imag
        C = (C_real + 1j * C_imag) * dt[:, None]
        pos = (lambda x, dt: x.to(dt))(torch.arange(L), log_dt.dtype)
        P = torch.exp((A * dt[:, None])[:, :, None] * pos[None, None, :])
        K = 2.0 * torch.einsum('dn,dnl->dl', C, P).real
        L2 = 2 * L
        u_t = (lambda x, *d: x.permute(*d))(u, 0, 2, 1)
        Kf = (lambda x, *a, **k: torch.fft.rfft(x.float(), *a, **k))(K, L2)
        Uf = (lambda x, *a, **k: torch.fft.rfft(x.float(), *a, **k))(u_t, L2)
        y = (lambda x, *a, **k: torch.fft.irfft(x, *a, **k).to(torch.bfloat16))(Uf * Kf[None, :, :], L2)[:, :, :L]
        y = (lambda x, *d: x.permute(*d))(y, 0, 2, 1)
        return y + u * D_skip[None, None, :]

    def _B_ref(x, w_gate, w_up, w_down):
        g = torch.einsum('bsd,df->bsf', x, w_gate)
        u = torch.einsum('bsd,df->bsf', x, w_up)
        h = _gelu(g) * u
        return torch.einsum('bsf,fd->bsd', h, w_down)
    x = A_u
    mod = (_silu(c) @ w_mod).reshape(c.shape[0], 6, 1, -1)
    sa, ca, ga, sb, cb, gb = (mod[:, 0].clone(), mod[:, 1].clone(), mod[:, 2].clone(), mod[:, 3].clone(), mod[:, 4].clone(), mod[:, 5].clone())
    h = _layernorm(x, axis=-1) * (1 + ca) + sa
    x = x + ga * _A_ref(h, A_log_A_real, A_A_imag, A_C_real, A_C_imag, A_log_dt, A_D_skip)
    h = _layernorm(x, axis=-1) * (1 + cb) + sb
    x = x + gb * _B_ref(h, B_w_gate, B_w_up, B_w_down)
    return x
```

```asm
; @launch kernel=k0_kernel grid=(256,1,1) block=(256,1,1) lds=139264
.amdgcn_target "amdgcn-amd-amdhsa--gfx950"
.text
.globl k0_kernel
.p2align 8
.type k0_kernel,@function
k0_kernel:
    s_load_dwordx16 s[8:23], s[0:1], 0
    s_load_dwordx16 s[24:39], s[0:1], 64
    s_cmp_ge_u32 s2, 256
    s_cbranch_scc1 K_end
    s_getpc_b64 s[4:5]
    v_lshlrev_b32 v37, 7, v0
    v_min_u32 v1, 0x7c80, v37
    global_load_dword v159, v1, s[4:5]
    s_and_b32 s6, s2, 7
    s_lshl_b32 s6, s6, 5
    s_lshr_b32 s41, s2, 3
    s_add_u32 s6, s6, s41
    s_lshl_b32 s40, s6, 9
    v_lshl_add_u32 v1, v0, 1, s40
    v_lshrrev_b32 v6, 7, v0
    s_lshl_b32 s41, s6, 2
    v_lshl_add_u32 v6, v6, 1, s41
    v_lshrrev_b32 v64, 6, v0
    v_and_b32 v65, 63, v0
    v_readfirstlane_b32 s7, v64
    s_lshl_b32 s42, s2, 13
    v_lshrrev_b32 v9, 5, v0
    v_lshlrev_b32 v9, 10, v9
    v_and_b32 v26, 31, v0
    v_lshl_add_u32 v9, v26, 4, v9
    v_add_u32 v9, s42, v9
    s_and_b32 s49, s2, 7
    s_lshr_b32 s40, s2, 3
    v_lshrrev_b32 v161, 4, v0
    v_and_b32 v162, 15, v0
    v_mul_u32_u24 v163, 24576, v161
    v_lshl_add_u32 v163, v162, 4, v163
    s_mul_i32 s42, s49, 393216
    s_lshl_b32 s43, s40, 8
    s_add_u32 s42, s42, s43
    v_add_u32 v163, s42, v163
    s_lshl_b32 s42, s49, 7
    v_lshl_add_u32 v164, v161, 3, s42
    v_mov_b32 v60, 0
    v_mov_b32 v61, 0
    v_mov_b32 v62, 0
    v_mov_b32 v63, 0
    s_cmp_lt_u32 s2, 192
    s_cselect_b32 s46, 3145728, 0
    s_mov_b32 s47, 0x20000
    s_lshl_b32 s3, s7, 8
    s_add_u32 s3, s3, s2
    s_cmp_lt_u32 s3, 1016
    s_waitcnt lgkmcnt(0)
    global_load_ushort v7, v6, s[18:19]
    global_load_ushort v2, v1, s[10:11]
    global_load_ushort v3, v1, s[12:13]
    global_load_ushort v4, v1, s[14:15]
    global_load_ushort v5, v1, s[16:17]
    s_mov_b32 s44, s32
    s_mov_b32 s45, s33
    global_load_dwordx4 v[18:21], v9, s[8:9]
    global_load_dwordx4 v[22:25], v9, s[8:9] offset:512
    global_load_dwordx2 v[168:169], v164, s[30:31]
    s_mov_b32 s48, 0
    buffer_load_dwordx4 v[176:179], v163, s[44:47], s48 offen
    s_mov_b32 s48, 6144
    buffer_load_dwordx4 v[180:183], v163, s[44:47], s48 offen
    s_mov_b32 s48, 12288
    buffer_load_dwordx4 v[184:187], v163, s[44:47], s48 offen
    s_mov_b32 s48, 18432
    buffer_load_dwordx4 v[188:191], v163, s[44:47], s48 offen
    s_load_dword s68, s[20:21], s41
    s_cbranch_scc1 P0_Z
    s_lshl_b32 s43, s2, 10
    s_add_u32 s43, s43, 0x25a000
    v_lshl_add_u32 v37, v65, 4, s43
    global_store_dwordx4 v37, v[60:63], s[38:39] sc1
P0_Z:
    v_lshrrev_b32 v165, 6, v0
    v_lshlrev_b32 v165, 9, v165
    v_lshl_add_u32 v165, v162, 5, v165
    v_bfe_u32 v166, v0, 4, 1
    v_lshl_add_u32 v165, v166, 3, v165
    v_bfe_u32 v166, v0, 5, 1
    v_lshl_add_u32 v165, v166, 2, v165
    v_add_u32 v165, 80384, v165
    s_mul_i32 s42, s49, 12288
    s_lshl_b32 s43, s40, 9
    s_add_u32 s42, s42, s43
    s_lshl_b32 s43, s7, 7
    s_add_u32 s42, s42, s43
    s_add_u32 s42, s42, 0x2a0000
    v_lshl_add_u32 v166, v26, 4, s42
    s_add_u32 s43, s43, 80384
    v_lshl_add_u32 v167, v26, 4, s43
    v_lshrrev_b32 v27, 5, v0
    v_mul_u32_u24 v27, 4640, v27
    v_lshl_add_u32 v27, v26, 4, v27
    ds_write_b128 v27, v[60:63] offset:38912
    v_bfe_u32 v27, v0, 5, 1
    v_mul_u32_u24 v27, 4224, v27
    v_lshl_add_u32 v27, v26, 2, v27
    v_add_u32 v27, 71936, v27
    ds_write_b32 v27, v60
    v_mul_u32_u24 v64, 8704, v64
    v_lshl_add_u32 v66, v65, 2, v64
    v_and_b32 v67, 15, v0
    v_bfe_u32 v68, v0, 4, 2
    v_mul_u32_u24 v69, 272, v67
    v_lshl_add_u32 v69, v68, 4, v69
    v_add_u32 v69, v64, v69
    v_and_b32 v70, 1, v68
    v_lshrrev_b32 v71, 1, v68
    v_lshlrev_b32 v72, 5, v67
    v_lshl_add_u32 v72, v70, 4, v72
    v_lshl_add_u32 v72, v71, 9, v72
    v_add_u32 v72, v64, v72
    v_sub_u32 v73, 4, v71
    v_lshlrev_b32 v73, v73, v67
    v_lshl_add_u32 v73, v68, 8, v73
    v_add_u32 v73, v64, v73
    v_mul_u32_u24 v74, 120, v71
    v_add_u32 v74, v73, v74
    v_lshlrev_b32 v75, 2, v67
    v_lshl_add_u32 v75, v68, 8, v75
    v_add_u32 v75, v64, v75
    s_mov_b32 s52, 0x05040100
    s_mov_b32 s53, 0x07060302
    s_mov_b32 s54, 0x3fb8aa3b
    s_mov_b32 s55, 0x3f803f80
    s_mul_i32 s43, s2, 8192
    s_lshl_b32 s42, s7, 11
    s_add_u32 s43, s43, s42
    v_lshl_add_u32 v8, v65, 4, s43
    v_lshrrev_b32 v9, 5, v0
    s_lshl_b32 s40, s2, 6
    s_add_u32 s40, s40, 0x280000
    v_lshl_add_u32 v9, v9, 3, s40
    s_and_b32 s66, s2, 3
    s_bfe_u32 s67, s2, 0x10002
    s_mul_i32 s67, s67, 22
    s_lshr_b32 s43, s2, 3
    s_add_u32 s67, s67, s43
    s_cmp_lt_u32 s67, 43
    s_cselect_b32 s69, 0x1000000, 0
    s_cmp_lt_u32 s2, 176
    s_cselect_b32 s69, s69, 0
    s_min_u32 s67, s67, 42
    s_sub_u32 s22, s2, 192
    s_min_u32 s22, s22, 64
    s_mul_i32 s22, s22, 3
    s_add_u32 s22, s22, s7
    s_sub_u32 s22, s22, 1
    s_cmp_eq_u32 s7, 0
    s_cselect_b32 s22, 255, s22
    s_mov_b32 s23, 0
    s_lshr_b32 s70, s7, 1
    s_and_b32 s71, s7, 1
    s_lshl_b32 s50, s66, 2
    s_add_u32 s50, s50, s7
    s_mul_i32 s50, s50, 88064
    s_lshl_b32 s51, s67, 6
    s_add_u32 s50, s50, s51
    v_lshrrev_b32 v10, 2, v65
    v_mul_u32_u24 v10, 2752, v10
    v_and_b32 v11, 3, v0
    v_xor_b32 v11, v11, v71
    v_lshl_add_u32 v10, v11, 4, v10
    v_add_u32 v10, s50, v10
    v_xor_b32 v11, 32, v10
    v_add_u32 v11, 44032, v11
    s_mul_i32 s41, s7, 4224
    s_add_u32 s41, s41, 101888
    s_lshr_b32 s42, s22, 2
    s_lshl_b32 s42, s42, 15
    s_and_b32 s43, s22, 3
    s_lshl_b32 s43, s43, 8
    s_add_u32 s23, s42, s43
    v_lshrrev_b32 v12, 1, v65
    v_lshl_add_u32 v12, v12, 10, s23
    v_and_b32 v13, 1, v0
    v_lshl_add_u32 v12, v13, 7, v12
    s_mov_b32 s48, s28
    s_mov_b32 s49, s29
    s_mov_b32 s50, 0x158000
    s_mov_b32 s51, 0x20000
    buffer_load_dword v13, v12, s[48:51], 0 offen
    v_lshlrev_b32 v28, 3, v0
    v_sub_u32 v28, 2047, v28
    v_subrev_u32 v29, 0, v28
    v_cvt_f32_u32 v39, v29
    v_cvt_pk_bf16_f32 v39, v39, v39
    v_and_b32 v39, 0xffff, v39
    v_subrev_u32 v39, 0x4280, v39
    v_cmp_gt_u32 vcc, 0x100, v29
    s_nop 1
    v_cndmask_b32 v148, v39, v29, vcc
    v_lshlrev_b32 v148, 2, v148
    v_subrev_u32 v29, 1, v28
    v_cvt_f32_u32 v39, v29
    v_cvt_pk_bf16_f32 v39, v39, v39
    v_and_b32 v39, 0xffff, v39
    v_subrev_u32 v39, 0x4280, v39
    v_cmp_gt_u32 vcc, 0x100, v29
    s_nop 1
    v_cndmask_b32 v149, v39, v29, vcc
    v_lshlrev_b32 v149, 2, v149
    v_subrev_u32 v29, 2, v28
    v_cvt_f32_u32 v39, v29
    v_cvt_pk_bf16_f32 v39, v39, v39
    v_and_b32 v39, 0xffff, v39
    v_subrev_u32 v39, 0x4280, v39
    v_cmp_gt_u32 vcc, 0x100, v29
    s_nop 1
    v_cndmask_b32 v150, v39, v29, vcc
    v_lshlrev_b32 v150, 2, v150
    v_subrev_u32 v29, 3, v28
    v_cvt_f32_u32 v39, v29
    v_cvt_pk_bf16_f32 v39, v39, v39
    v_and_b32 v39, 0xffff, v39
    v_subrev_u32 v39, 0x4280, v39
    v_cmp_gt_u32 vcc, 0x100, v29
    s_nop 1
    v_cndmask_b32 v151, v39, v29, vcc
    v_lshlrev_b32 v151, 2, v151
    v_subrev_u32 v29, 4, v28
    v_cvt_f32_u32 v39, v29
    v_cvt_pk_bf16_f32 v39, v39, v39
    v_and_b32 v39, 0xffff, v39
    v_subrev_u32 v39, 0x4280, v39
    v_cmp_gt_u32 vcc, 0x100, v29
    s_nop 1
    v_cndmask_b32 v152, v39, v29, vcc
    v_lshlrev_b32 v152, 2, v152
    v_subrev_u32 v29, 5, v28
    v_cvt_f32_u32 v39, v29
    v_cvt_pk_bf16_f32 v39, v39, v39
    v_and_b32 v39, 0xffff, v39
    v_subrev_u32 v39, 0x4280, v39
    v_cmp_gt_u32 vcc, 0x100, v29
    s_nop 1
    v_cndmask_b32 v153, v39, v29, vcc
    v_lshlrev_b32 v153, 2, v153
    v_subrev_u32 v29, 6, v28
    v_cvt_f32_u32 v39, v29
    v_cvt_pk_bf16_f32 v39, v39, v39
    v_and_b32 v39, 0xffff, v39
    v_subrev_u32 v39, 0x4280, v39
    v_cmp_gt_u32 vcc, 0x100, v29
    s_nop 1
    v_cndmask_b32 v154, v39, v29, vcc
    v_lshlrev_b32 v154, 2, v154
    v_subrev_u32 v29, 7, v28
    v_cvt_f32_u32 v39, v29
    v_cvt_pk_bf16_f32 v39, v39, v39
    v_and_b32 v39, 0xffff, v39
    v_subrev_u32 v39, 0x4280, v39
    v_cmp_gt_u32 vcc, 0x100, v29
    s_nop 1
    v_cndmask_b32 v155, v39, v29, vcc
    v_lshlrev_b32 v155, 2, v155
    v_subrev_u32 v29, 8, v28
    v_cvt_f32_u32 v39, v29
    v_cvt_pk_bf16_f32 v39, v39, v39
    v_and_b32 v39, 0xffff, v39
    v_subrev_u32 v39, 0x4280, v39
    v_min_u32 v39, 0x300, v39
    v_cmp_gt_u32 vcc, 0x100, v29
    s_nop 1
    v_cndmask_b32 v156, v39, v29, vcc
    v_lshlrev_b32 v156, 2, v156
    v_subrev_u32 v29, 9, v28
    v_cvt_f32_u32 v39, v29
    v_cvt_pk_bf16_f32 v39, v39, v39
    v_and_b32 v39, 0xffff, v39
    v_subrev_u32 v39, 0x4280, v39
    v_min_u32 v39, 0x300, v39
    v_cmp_gt_u32 vcc, 0x100, v29
    s_nop 1
    v_cndmask_b32 v157, v39, v29, vcc
    v_lshlrev_b32 v157, 2, v157
    v_subrev_u32 v29, 10, v28
    v_cvt_f32_u32 v39, v29
    v_cvt_pk_bf16_f32 v39, v39, v39
    v_and_b32 v39, 0xffff, v39
    v_subrev_u32 v39, 0x4280, v39
    v_min_u32 v39, 0x300, v39
    v_cmp_gt_u32 vcc, 0x100, v29
    s_nop 1
    v_cndmask_b32 v158, v39, v29, vcc
    v_lshlrev_b32 v158, 2, v158
    v_lshrrev_b32 v16, 5, v0
    v_mul_u32_u24 v16, 1152, v16
    v_lshl_add_u32 v16, v26, 4, v16
    v_add_u32 v16, 85504, v16
    v_bfe_u32 v17, v0, 2, 2
    v_mul_u32_u24 v17, 1152, v17
    v_lshl_add_u32 v17, v68, 5, v17
    v_and_b32 v27, 3, v0
    v_lshl_add_u32 v17, v27, 3, v17
    s_lshl_b32 s42, s7, 8
    s_add_u32 s42, s42, 85504
    v_add_u32 v17, s42, v17
    v_mov_b32 v32, 0
    v_mov_b32 v33, 0
    s_cmp_ge_u32 s3, 1016
    s_waitcnt vmcnt(9)
    s_cbranch_scc1 P0_Z1
    s_waitcnt vmcnt(8)
P0_Z1:
    v_mov_b32 v159, 1
    v_lshlrev_b32 v7, 16, v7
    v_lshlrev_b32 v2, 16, v2
    v_lshlrev_b32 v3, 16, v3
    v_lshlrev_b32 v4, 16, v4
    v_lshlrev_b32 v5, 16, v5
    v_mul_f32 v7, s54, v7
    v_mul_f32 v2, s54, v2
    v_exp_f32 v7, v7
    v_exp_f32 v2, v2
    v_max_f32 v39, abs(v4), abs(v5)
    v_cvt_pk_bf16_f32 v7, v7, v2
    v_and_b32 v2, 0xffff0000, v7
    v_lshlrev_b32 v7, 16, v7
    v_max_f32_dpp v39, v39, v39 row_shr:1 row_mask:0xf bank_mask:0xf
    s_nop 1
    v_max_f32_dpp v39, v39, v39 row_shr:2 row_mask:0xf bank_mask:0xf
    s_nop 1
    v_max_f32_dpp v39, v39, v39 row_shr:4 row_mask:0xf bank_mask:0xf
    s_nop 1
    v_max_f32_dpp v39, v39, v39 row_shr:8 row_mask:0xf bank_mask:0xf
    s_nop 1
    v_max_f32_dpp v39, v39, v39 row_bcast:15 row_mask:0xa bank_mask:0xf
    s_nop 1
    v_max_f32_dpp v39, v39, v39 row_bcast:31 row_mask:0xc bank_mask:0xf
    v_mul_f32 v40, v2, v7
    v_mul_f32 v41, v3, v7
    v_readlane_b32 s56, v39, 63
    v_mul_f32 v40, s54, v40
    v_mul_f32 v41, 0x3e22f983, v41
    s_lshr_b32 s56, s56, 23
    s_max_u32 s56, s56, 13
    s_min_u32 s56, s56, 254
    s_sub_u32 s57, 267, s56
    s_lshl_b32 s57, s57, 23
    s_sub_u32 s56, s56, 12
    s_lshl_b32 s56, s56, 23
    v_mul_f32 v44, 0xc1000000, v40
    v_mul_f32 v45, 0xc1000000, v41
    v_exp_f32 v29, v44
    v_fract_f32 v45, v45
    v_cos_f32 v44, v45
    v_sin_f32 v45, v45
    v_mul_f32 v44, v44, v29
    v_mul_f32 v45, v45, v29
    v_mul_f32 v82, 0xbf800000, v40
    v_mul_f32 v83, 0x3f800000, v41
    v_exp_f32 v29, v82
    v_fract_f32 v83, v83
    v_cos_f32 v82, v83
    v_sin_f32 v83, v83
    v_mul_f32 v82, v82, v29
    v_mul_f32 v83, v83, v29
    v_mul_f32 v46, 0xc3000000, v40
    v_mul_f32 v47, 0x43000000, v41
    v_exp_f32 v29, v46
    v_fract_f32 v47, v47
    v_cos_f32 v46, v47
    v_sin_f32 v47, v47
    v_mul_f32 v46, v46, v29
    v_mul_f32 v47, v47, v29
    v_mul_f32 v48, s57, v4
    v_mul_f32 v49, s57, -v5
    v_mul_f32 v7, s56, v7
    v_mov_b32 v42, 0x3c00
    ds_write_b32 v66, v42 offset:4352
    v_cvt_pk_f16_f32 v60, v48, v49
    ds_write_b32 v66, v60 offset:0
    v_cvt_pk_f16_f32 v61, v82, v83
    ds_write_b32 v66, v61 offset:4624
    v_cvt_pk_f16_f32 v62, v46, v47
    ds_write_b32 v66, v62 offset:6528
    v_pk_mul_f32 v[56:57], v[48:49], v[44:45] op_sel:[1,1] op_sel_hi:[1,0] neg_lo:[1,0]
    v_pk_mul_f32 v[58:59], v[82:83], v[46:47] op_sel:[1,1] op_sel_hi:[1,0] neg_lo:[1,0]
    v_pk_fma_f32 v[50:51], v[48:49], v[44:45], v[56:57] op_sel:[0,0,0] op_sel_hi:[0,1,1]
    v_pk_fma_f32 v[76:77], v[82:83], v[46:47], v[58:59] op_sel:[0,0,0] op_sel_hi:[0,1,1]
    v_cvt_pk_f16_f32 v63, v50, v51
    v_cvt_pk_f16_f32 v60, v76, v77
    ds_write_b32 v66, v63 offset:272
    ds_write_b32 v66, v60 offset:6800
    s_cmp_lg_u32 s7, 3
    s_cbranch_scc1 P0_F
    s_mov_b64 exec, 1
    global_load_dword v38, v32, s[36:37]
    s_mov_b64 exec, -1
P0_F:
    v_pk_mul_f32 v[56:57], v[50:51], v[44:45] op_sel:[1,1] op_sel_hi:[1,0] neg_lo:[1,0]
    v_pk_mul_f32 v[58:59], v[82:83], v[82:83] op_sel:[1,1] op_sel_hi:[1,0] neg_lo:[1,0]
    v_pk_fma_f32 v[48:49], v[50:51], v[44:45], v[56:57] op_sel:[0,0,0] op_sel_hi:[0,1,1]
    v_pk_fma_f32 v[84:85], v[82:83], v[82:83], v[58:59] op_sel:[0,0,0] op_sel_hi:[0,1,1]
    v_cvt_pk_f16_f32 v61, v48, v49
    v_cvt_pk_f16_f32 v62, v84, v85
    ds_write_b32 v66, v61 offset:544
    ds_write_b32 v66, v62 offset:4896
    v_pk_mul_f32 v[56:57], v[48:49], v[44:45] op_sel:[1,1] op_sel_hi:[1,0] neg_lo:[1,0]
    v_pk_mul_f32 v[58:59], v[84:85], v[46:47] op_sel:[1,1] op_sel_hi:[1,0] neg_lo:[1,0]
    v_pk_fma_f32 v[50:51], v[48:49], v[44:45], v[56:57] op_sel:[0,0,0] op_sel_hi:[0,1,1]
    v_pk_fma_f32 v[76:77], v[84:85], v[46:47], v[58:59] op_sel:[0,0,0] op_sel_hi:[0,1,1]
    v_cvt_pk_f16_f32 v63, v50, v51
    v_cvt_pk_f16_f32 v60, v76, v77
    ds_write_b32 v66, v63 offset:816
    ds_write_b32 v66, v60 offset:7072
    v_pk_mul_f32 v[56:57], v[50:51], v[44:45] op_sel:[1,1] op_sel_hi:[1,0] neg_lo:[1,0]
    v_pk_mul_f32 v[58:59], v[84:85], v[82:83] op_sel:[1,1] op_sel_hi:[1,0] neg_lo:[1,0]
    v_pk_fma_f32 v[48:49], v[50:51], v[44:45], v[56:57] op_sel:[0,0,0] op_sel_hi:[0,1,1]
    v_pk_fma_f32 v[86:87], v[84:85], v[82:83], v[58:59] op_sel:[0,0,0] op_sel_hi:[0,1,1]
    v_cvt_pk_f16_f32 v61, v48, v49
    v_cvt_pk_f16_f32 v62, v86, v87
    ds_write_b32 v66, v61 offset:1088
    ds_write_b32 v66, v62 offset:5168
    v_pk_mul_f32 v[56:57], v[48:49], v[44:45] op_sel:[1,1] op_sel_hi:[1,0] neg_lo:[1,0]
    v_pk_mul_f32 v[58:59], v[86:87], v[46:47] op_sel:[1,1] op_sel_hi:[1,0] neg_lo:[1,0]
    v_pk_fma_f32 v[50:51], v[48:49], v[44:45], v[56:57] op_sel:[0,0,0] op_sel_hi:[0,1,1]
    v_pk_fma_f32 v[78:79], v[86:87], v[46:47], v[58:59] op_sel:[0,0,0] op_sel_hi:[0,1,1]
    v_cvt_pk_f16_f32 v63, v50, v51
    v_cvt_pk_f16_f32 v60, v78, v79
    ds_write_b32 v66, v63 offset:1360
    ds_write_b32 v66, v60 offset:7344
    v_pk_mul_f32 v[56:57], v[50:51], v[44:45] op_sel:[1,1] op_sel_hi:[1,0] neg_lo:[1,0]
    v_pk_mul_f32 v[58:59], v[86:87], v[82:83] op_sel:[1,1] op_sel_hi:[1,0] neg_lo:[1,0]
    v_pk_fma_f32 v[48:49], v[50:51], v[44:45], v[56:57] op_sel:[0,0,0] op_sel_hi:[0,1,1]
    v_pk_fma_f32 v[88:89], v[86:87], v[82:83], v[58:59] op_sel:[0,0,0] op_sel_hi:[0,1,1]
    v_cvt_pk_f16_f32 v61, v48, v49
    v_cvt_pk_f16_f32 v62, v88, v89
    ds_write_b32 v66, v61 offset:1632
    ds_write_b32 v66, v62 offset:5440
    v_pk_mul_f32 v[56:57], v[48:49], v[44:45] op_sel:[1,1] op_sel_hi:[1,0] neg_lo:[1,0]
    v_pk_mul_f32 v[58:59], v[88:89], v[46:47] op_sel:[1,1] op_sel_hi:[1,0] neg_lo:[1,0]
    v_pk_fma_f32 v[50:51], v[48:49], v[44:45], v[56:57] op_sel:[0,0,0] op_sel_hi:[0,1,1]
    v_pk_fma_f32 v[76:77], v[88:89], v[46:47], v[58:59] op_sel:[0,0,0] op_sel_hi:[0,1,1]
    v_cvt_pk_f16_f32 v63, v50, v51
    v_cvt_pk_f16_f32 v60, v76, v77
    ds_write_b32 v66, v63 offset:1904
    ds_write_b32 v66, v60 offset:7616
    v_pk_mul_f32 v[56:57], v[50:51], v[44:45] op_sel:[1,1] op_sel_hi:[1,0] neg_lo:[1,0]
    v_pk_mul_f32 v[58:59], v[88:89], v[82:83] op_sel:[1,1] op_sel_hi:[1,0] neg_lo:[1,0]
    v_pk_fma_f32 v[48:49], v[50:51], v[44:45], v[56:57] op_sel:[0,0,0] op_sel_hi:[0,1,1]
    v_pk_fma_f32 v[90:91], v[88:89], v[82:83], v[58:59] op_sel:[0,0,0] op_sel_hi:[0,1,1]
    v_cvt_pk_f16_f32 v61, v48, v49
    v_cvt_pk_f16_f32 v62, v90, v91
    ds_write_b32 v66, v61 offset:2176
    ds_write_b32 v66, v62 offset:5712
    v_pk_mul_f32 v[56:57], v[48:49], v[44:45] op_sel:[1,1] op_sel_hi:[1,0] neg_lo:[1,0]
    v_pk_mul_f32 v[58:59], v[90:91], v[46:47] op_sel:[1,1] op_sel_hi:[1,0] neg_lo:[1,0]
    v_pk_fma_f32 v[50:51], v[48:49], v[44:45], v[56:57] op_sel:[0,0,0] op_sel_hi:[0,1,1]
    v_pk_fma_f32 v[78:79], v[90:91], v[46:47], v[58:59] op_sel:[0,0,0] op_sel_hi:[0,1,1]
    v_cvt_pk_f16_f32 v63, v50, v51
    v_cvt_pk_f16_f32 v60, v78, v79
    ds_write_b32 v66, v63 offset:2448
    ds_write_b32 v66, v60 offset:7888
    v_pk_mul_f32 v[56:57], v[50:51], v[44:45] op_sel:[1,1] op_sel_hi:[1,0] neg_lo:[1,0]
    v_pk_mul_f32 v[58:59], v[90:91], v[82:83] op_sel:[1,1] op_sel_hi:[1,0] neg_lo:[1,0]
    v_pk_fma_f32 v[48:49], v[50:51], v[44:45], v[56:57] op_sel:[0,0,0] op_sel_hi:[0,1,1]
    v_pk_fma_f32 v[92:93], v[90:91], v[82:83], v[58:59] op_sel:[0,0,0] op_sel_hi:[0,1,1]
    v_cvt_pk_f16_f32 v61, v48, v49
    v_cvt_pk_f16_f32 v62, v92, v93
    ds_write_b32 v66, v61 offset:2720
    ds_write_b32 v66, v62 offset:5984
    v_pk_mul_f32 v[56:57], v[48:49], v[44:45] op_sel:[1,1] op_sel_hi:[1,0] neg_lo:[1,0]
    v_pk_mul_f32 v[58:59], v[92:93], v[46:47] op_sel:[1,1] op_sel_hi:[1,0] neg_lo:[1,0]
    v_pk_fma_f32 v[50:51], v[48:49], v[44:45], v[56:57] op_sel:[0,0,0] op_sel_hi:[0,1,1]
    v_pk_fma_f32 v[76:77], v[92:93], v[46:47], v[58:59] op_sel:[0,0,0] op_sel_hi:[0,1,1]
    v_cvt_pk_f16_f32 v63, v50, v51
    v_cvt_pk_f16_f32 v60, v76, v77
    ds_write_b32 v66, v63 offset:2992
    ds_write_b32 v66, v60 offset:8160
    v_pk_mul_f32 v[56:57], v[50:51], v[44:45] op_sel:[1,1] op_sel_hi:[1,0] neg_lo:[1,0]
    v_pk_mul_f32 v[58:59], v[92:93], v[82:83] op_sel:[1,1] op_sel_hi:[1,0] neg_lo:[1,0]
    v_pk_fma_f32 v[48:49], v[50:51], v[44:45], v[56:57] op_sel:[0,0,0] op_sel_hi:[0,1,1]
    v_pk_fma_f32 v[94:95], v[92:93], v[82:83], v[58:59] op_sel:[0,0,0] op_sel_hi:[0,1,1]
    v_cvt_pk_f16_f32 v61, v48, v49
    v_cvt_pk_f16_f32 v62, v94, v95
    ds_write_b32 v66, v61 offset:3264
    ds_write_b32 v66, v62 offset:6256
    v_pk_mul_f32 v[56:57], v[48:49], v[44:45] op_sel:[1,1] op_sel_hi:[1,0] neg_lo:[1,0]
    v_pk_mul_f32 v[58:59], v[94:95], v[46:47] op_sel:[1,1] op_sel_hi:[1,0] neg_lo:[1,0]
    v_pk_fma_f32 v[50:51], v[48:49], v[44:45], v[56:57] op_sel:[0,0,0] op_sel_hi:[0,1,1]
    v_pk_fma_f32 v[78:79], v[94:95], v[46:47], v[58:59] op_sel:[0,0,0] op_sel_hi:[0,1,1]
    v_cvt_pk_f16_f32 v63, v50, v51
    v_cvt_pk_f16_f32 v60, v78, v79
    ds_write_b32 v66, v63 offset:3536
    ds_write_b32 v66, v60 offset:8432
    v_pk_mul_f32 v[56:57], v[50:51], v[44:45] op_sel:[1,1] op_sel_hi:[1,0] neg_lo:[1,0]
    v_pk_mul_f32 v[58:59], v[46:47], v[46:47] op_sel:[1,1] op_sel_hi:[1,0] neg_lo:[1,0]
    v_pk_fma_f32 v[48:49], v[50:51], v[44:45], v[56:57] op_sel:[0,0,0] op_sel_hi:[0,1,1]
    v_pk_fma_f32 v[52:53], v[46:47], v[46:47], v[58:59] op_sel:[0,0,0] op_sel_hi:[0,1,1]
    v_cvt_pk_f16_f32 v61, v48, v49
    ds_write_b32 v66, v61 offset:3808
    v_pk_mul_f32 v[56:57], v[48:49], v[44:45] op_sel:[1,1] op_sel_hi:[1,0] neg_lo:[1,0]
    v_pk_fma_f32 v[50:51], v[48:49], v[44:45], v[56:57] op_sel:[0,0,0] op_sel_hi:[0,1,1]
    v_cvt_pk_f16_f32 v62, v50, v51
    ds_write_b32 v66, v62 offset:4080
    s_waitcnt lgkmcnt(0)
    ds_read_b128 v[96:99], v69 offset:0
    ds_read_b128 v[100:103], v69 offset:64
    ds_read_b128 v[104:107], v69 offset:128
    ds_read_b128 v[108:111], v69 offset:192
    ds_read_b128 v[112:115], v69 offset:4352
    ds_read_b128 v[116:119], v69 offset:4416
    ds_read_b128 v[120:123], v69 offset:4480
    ds_read_b128 v[124:127], v69 offset:4544
    v_mov_b32 v94, v52
    v_mov_b32 v95, v53
    s_cmp_ge_u32 s2, 192
    s_waitcnt vmcnt(6)
    ds_write_b128 v16, v[18:21]
    ds_write_b128 v16, v[22:25] offset:512
    v_dot2_f32_bf16 v32, v18, s55, v32
    v_dot2_f32_bf16 v33, v18, v18, v33
    v_dot2_f32_bf16 v32, v19, s55, v32
    v_dot2_f32_bf16 v33, v19, v19, v33
    v_dot2_f32_bf16 v32, v20, s55, v32
    v_dot2_f32_bf16 v33, v20, v20, v33
    v_dot2_f32_bf16 v32, v21, s55, v32
    v_dot2_f32_bf16 v33, v21, v21, v33
    v_dot2_f32_bf16 v32, v22, s55, v32
    v_dot2_f32_bf16 v33, v22, v22, v33
    v_dot2_f32_bf16 v32, v23, s55, v32
    v_dot2_f32_bf16 v33, v23, v23, v33
    v_dot2_f32_bf16 v32, v24, s55, v32
    v_dot2_f32_bf16 v33, v24, v24, v33
    v_dot2_f32_bf16 v32, v25, s55, v32
    v_dot2_f32_bf16 v33, v25, v25, v33
    s_nop 1
    v_add_f32_dpp v32, v32, v32 row_shr:1 row_mask:0xf bank_mask:0xf
    v_add_f32_dpp v33, v33, v33 row_shr:1 row_mask:0xf bank_mask:0xf
    s_nop 0
    v_add_f32_dpp v32, v32, v32 row_shr:2 row_mask:0xf bank_mask:0xf
    v_add_f32_dpp v33, v33, v33 row_shr:2 row_mask:0xf bank_mask:0xf
    s_nop 0
    v_add_f32_dpp v32, v32, v32 row_shr:4 row_mask:0xf bank_mask:0xf
    v_add_f32_dpp v33, v33, v33 row_shr:4 row_mask:0xf bank_mask:0xf
    s_nop 0
    v_add_f32_dpp v32, v32, v32 row_shr:8 row_mask:0xf bank_mask:0xf
    v_add_f32_dpp v33, v33, v33 row_shr:8 row_mask:0xf bank_mask:0xf
    s_nop 0
    v_add_f32_dpp v32, v32, v32 row_bcast:15 row_mask:0xa bank_mask:0xf
    v_add_f32_dpp v33, v33, v33 row_bcast:15 row_mask:0xa bank_mask:0xf
    v_mul_f32 v32, 0x3b000000, v32
    v_mul_f32 v36, v32, v32
    v_mul_f32 v33, 0x3b000000, v33
    v_sub_f32 v33, v33, v36
    v_max_f32 v33, 0, v33
    v_cvt_pk_bf16_f32 v36, v32, v33
    v_lshlrev_b32 v32, 16, v36
    v_and_b32 v33, 0xffff0000, v36
    v_add_f32 v33, 0x3727c5ac, v33
    v_cvt_pk_bf16_f32 v33, v33, v33
    v_lshlrev_b32 v33, 16, v33
    v_sqrt_f32 v33, v33
    s_nop 0
    v_cvt_pk_bf16_f32 v33, v33, v33
    v_lshlrev_b32 v33, 16, v33
    v_rcp_f32 v34, v33
    s_nop 0
    v_mul_f32 v35, -v32, v34
    s_mov_b32 exec_lo, 0x80000000
    s_mov_b32 exec_hi, 0x80000000
    global_store_dwordx2 v9, v[34:35], s[38:39] sc1
    s_mov_b64 exec, -1
    s_cmp_lt_u32 s2, 248
    s_cbranch_scc1 P0_X
    v_mov_b32 v240, 0
    v_mov_b32 v241, 0
    v_mov_b32 v242, 0
    v_mov_b32 v243, 0
    s_lshl_b32 s43, s2, 12
    s_add_u32 s43, s43, 0x198000
    v_lshl_add_u32 v37, v0, 4, s43
    global_store_dwordx4 v37, v[240:243], s[38:39] sc1
    s_cmp_lt_u32 s3, 1016
    s_cbranch_scc1 P0_X
    s_lshl_b32 s43, s2, 2
    v_mov_b32 v37, s43
    s_waitcnt vmcnt(3)
    s_mov_b64 exec, 1
    global_store_dword v37, v159, s[36:37] offset:-864 sc1
    s_mov_b64 exec, -1
P0_X:
    v_lshlrev_b32 v37, 2, v65
    s_waitcnt lgkmcnt(0)
    v_mfma_f32_16x16x32_f16 v[136:139], v[112:115], v[96:99], 0
    v_mfma_f32_16x16x32_f16 v[136:139], v[116:119], v[100:103], v[136:139]
    v_mfma_f32_16x16x32_f16 v[136:139], v[120:123], v[104:107], v[136:139]
    v_mfma_f32_16x16x32_f16 v[136:139], v[124:127], v[108:111], v[136:139]
    v_cvt_pk_f16_f32 v63, v52, v53
    ds_write_b32 v66, v63 offset:0
    v_pk_mul_f32 v[56:57], v[52:53], v[46:47] op_sel:[1,1] op_sel_hi:[1,0] neg_lo:[1,0]
    v_pk_mul_f32 v[58:59], v[52:53], v[84:85] op_sel:[1,1] op_sel_hi:[1,0] neg_lo:[1,0]
    v_pk_fma_f32 v[54:55], v[52:53], v[46:47], v[56:57] op_sel:[0,0,0] op_sel_hi:[0,1,1]
    v_pk_fma_f32 v[76:77], v[52:53], v[84:85], v[58:59] op_sel:[0,0,0] op_sel_hi:[0,1,1]
    v_cvt_pk_f16_f32 v60, v54, v55
    v_cvt_pk_f16_f32 v61, v76, v77
    ds_write_b32 v66, v60 offset:1088
    ds_write_b32 v66, v61 offset:272
    v_pk_mul_f32 v[56:57], v[52:53], v[88:89] op_sel:[1,1] op_sel_hi:[1,0] neg_lo:[1,0]
    v_pk_mul_f32 v[58:59], v[52:53], v[92:93] op_sel:[1,1] op_sel_hi:[1,0] neg_lo:[1,0]
    v_pk_fma_f32 v[78:79], v[52:53], v[88:89], v[56:57] op_sel:[0,0,0] op_sel_hi:[0,1,1]
    v_pk_fma_f32 v[76:77], v[52:53], v[92:93], v[58:59] op_sel:[0,0,0] op_sel_hi:[0,1,1]
    v_cvt_pk_f16_f32 v62, v78, v79
    v_cvt_pk_f16_f32 v63, v76, v77
    ds_write_b32 v66, v62 offset:544
    ds_write_b32 v66, v63 offset:816
    v_pk_mul_f32 v[56:57], v[54:55], v[46:47] op_sel:[1,1] op_sel_hi:[1,0] neg_lo:[1,0]
    v_pk_mul_f32 v[58:59], v[54:55], v[84:85] op_sel:[1,1] op_sel_hi:[1,0] neg_lo:[1,0]
    v_pk_fma_f32 v[48:49], v[54:55], v[46:47], v[56:57] op_sel:[0,0,0] op_sel_hi:[0,1,1]
    v_pk_fma_f32 v[76:77], v[54:55], v[84:85], v[58:59] op_sel:[0,0,0] op_sel_hi:[0,1,1]
    v_cvt_pk_f16_f32 v60, v48, v49
    v_cvt_pk_f16_f32 v61, v76, v77
    ds_write_b32 v66, v60 offset:2176
    ds_write_b32 v66, v61 offset:1360
    v_pk_mul_f32 v[56:57], v[54:55], v[88:89] op_sel:[1,1] op_sel_hi:[1,0] neg_lo:[1,0]
    v_pk_mul_f32 v[58:59], v[54:55], v[92:93] op_sel:[1,1] op_sel_hi:[1,0] neg_lo:[1,0]
    v_pk_fma_f32 v[78:79], v[54:55], v[88:89], v[56:57] op_sel:[0,0,0] op_sel_hi:[0,1,1]
    v_pk_fma_f32 v[76:77], v[54:55], v[92:93], v[58:59] op_sel:[0,0,0] op_sel_hi:[0,1,1]
    v_cvt_pk_f16_f32 v62, v78, v79
    v_cvt_pk_f16_f32 v63, v76, v77
    ds_write_b32 v66, v62 offset:1632
    ds_write_b32 v66, v63 offset:1904
    v_pk_mul_f32 v[56:57], v[48:49], v[46:47] op_sel:[1,1] op_sel_hi:[1,0] neg_lo:[1,0]
    v_pk_mul_f32 v[58:59], v[48:49], v[88:89] op_sel:[1,1] op_sel_hi:[1,0] neg_lo:[1,0]
    v_pk_fma_f32 v[52:53], v[48:49], v[46:47], v[56:57] op_sel:[0,0,0] op_sel_hi:[0,1,1]
    v_pk_fma_f32 v[76:77], v[48:49], v[88:89], v[58:59] op_sel:[0,0,0] op_sel_hi:[0,1,1]
    v_cvt_pk_f16_f32 v60, v52, v53
    v_cvt_pk_f16_f32 v61, v76, v77
    ds_write_b32 v66, v60 offset:2720
    ds_write_b32 v66, v61 offset:2448
    v_pk_mul_f32 v[56:57], v[52:53], v[46:47] op_sel:[1,1] op_sel_hi:[1,0] neg_lo:[1,0]
    v_pk_mul_f32 v[58:59], v[52:53], v[88:89] op_sel:[1,1] op_sel_hi:[1,0] neg_lo:[1,0]
    v_pk_fma_f32 v[54:55], v[52:53], v[46:47], v[56:57] op_sel:[0,0,0] op_sel_hi:[0,1,1]
    v_pk_fma_f32 v[76:77], v[52:53], v[88:89], v[58:59] op_sel:[0,0,0] op_sel_hi:[0,1,1]
    v_cvt_pk_f16_f32 v62, v54, v55
    v_cvt_pk_f16_f32 v63, v76, v77
    ds_write_b32 v66, v62 offset:3264
    ds_write_b32 v66, v63 offset:2992
    v_pk_mul_f32 v[56:57], v[54:55], v[46:47] op_sel:[1,1] op_sel_hi:[1,0] neg_lo:[1,0]
    v_pk_mul_f32 v[58:59], v[54:55], v[88:89] op_sel:[1,1] op_sel_hi:[1,0] neg_lo:[1,0]
    v_pk_fma_f32 v[48:49], v[54:55], v[46:47], v[56:57] op_sel:[0,0,0] op_sel_hi:[0,1,1]
    v_pk_fma_f32 v[76:77], v[54:55], v[88:89], v[58:59] op_sel:[0,0,0] op_sel_hi:[0,1,1]
    v_cvt_pk_f16_f32 v60, v48, v49
    v_cvt_pk_f16_f32 v61, v76, v77
    ds_write_b32 v66, v60 offset:3808
    ds_write_b32 v66, v61 offset:3536
    v_pk_mul_f32 v[56:57], v[48:49], v[46:47] op_sel:[1,1] op_sel_hi:[1,0] neg_lo:[1,0]
    v_pk_mul_f32 v[58:59], v[48:49], v[88:89] op_sel:[1,1] op_sel_hi:[1,0] neg_lo:[1,0]
    v_pk_fma_f32 v[52:53], v[48:49], v[46:47], v[56:57] op_sel:[0,0,0] op_sel_hi:[0,1,1]
    v_pk_fma_f32 v[76:77], v[48:49], v[88:89], v[58:59] op_sel:[0,0,0] op_sel_hi:[0,1,1]
    v_cvt_pk_f16_f32 v62, v52, v53
    v_cvt_pk_f16_f32 v63, v76, v77
    ds_write_b32 v66, v62 offset:4352
    ds_write_b32 v66, v63 offset:4080
    v_pk_mul_f32 v[56:57], v[48:49], v[94:95] op_sel:[1,1] op_sel_hi:[1,0] neg_lo:[1,0]
    v_pk_mul_f32 v[58:59], v[52:53], v[94:95] op_sel:[1,1] op_sel_hi:[1,0] neg_lo:[1,0]
    v_pk_fma_f32 v[82:83], v[48:49], v[94:95], v[56:57] op_sel:[0,0,0] op_sel_hi:[0,1,1]
    v_pk_fma_f32 v[90:91], v[52:53], v[94:95], v[58:59] op_sel:[0,0,0] op_sel_hi:[0,1,1]
    v_cvt_pk_f16_f32 v60, v82, v83
    v_cvt_pk_f16_f32 v61, v90, v91
    ds_write_b32 v66, v60 offset:4624
    ds_write_b32 v66, v61 offset:4896
    v_pk_mul_f32 v[56:57], v[82:83], v[94:95] op_sel:[1,1] op_sel_hi:[1,0] neg_lo:[1,0]
    v_pk_mul_f32 v[58:59], v[90:91], v[94:95] op_sel:[1,1] op_sel_hi:[1,0] neg_lo:[1,0]
    v_pk_fma_f32 v[50:51], v[82:83], v[94:95], v[56:57] op_sel:[0,0,0] op_sel_hi:[0,1,1]
    v_pk_fma_f32 v[86:87], v[90:91], v[94:95], v[58:59] op_sel:[0,0,0] op_sel_hi:[0,1,1]
    v_cvt_pk_f16_f32 v62, v50, v51
    v_cvt_pk_f16_f32 v63, v86, v87
    ds_write_b32 v66, v62 offset:5168
    ds_write_b32 v66, v63 offset:5440
    v_pk_mul_f32 v[56:57], v[50:51], v[94:95] op_sel:[1,1] op_sel_hi:[1,0] neg_lo:[1,0]
    v_pk_mul_f32 v[58:59], v[86:87], v[94:95] op_sel:[1,1] op_sel_hi:[1,0] neg_lo:[1,0]
    v_pk_fma_f32 v[82:83], v[50:51], v[94:95], v[56:57] op_sel:[0,0,0] op_sel_hi:[0,1,1]
    v_pk_fma_f32 v[90:91], v[86:87], v[94:95], v[58:59] op_sel:[0,0,0] op_sel_hi:[0,1,1]
    v_cvt_pk_f16_f32 v60, v82, v83
    v_cvt_pk_f16_f32 v61, v90, v91
    ds_write_b32 v66, v60 offset:5712
    ds_write_b32 v66, v61 offset:5984
    v_pk_mul_f32 v[56:57], v[82:83], v[94:95] op_sel:[1,1] op_sel_hi:[1,0] neg_lo:[1,0]
    v_pk_mul_f32 v[58:59], v[90:91], v[94:95] op_sel:[1,1] op_sel_hi:[1,0] neg_lo:[1,0]
    v_pk_fma_f32 v[50:51], v[82:83], v[94:95], v[56:57] op_sel:[0,0,0] op_sel_hi:[0,1,1]
    v_pk_fma_f32 v[86:87], v[90:91], v[94:95], v[58:59] op_sel:[0,0,0] op_sel_hi:[0,1,1]
    v_cvt_pk_f16_f32 v62, v50, v51
    v_cvt_pk_f16_f32 v63, v86, v87
    ds_write_b32 v66, v62 offset:6256
    ds_write_b32 v66, v63 offset:6528
    s_waitcnt lgkmcnt(0)
    ds_read_b128 v[112:115], v69 offset:0
    ds_read_b128 v[116:119], v69 offset:64
    ds_read_b128 v[120:123], v69 offset:128
    ds_read_b128 v[124:127], v69 offset:192
    ds_read_b128 v[76:79], v69 offset:4352
    ds_read_b128 v[80:83], v69 offset:4416
    ds_read_b128 v[84:87], v69 offset:4480
    ds_read_b128 v[88:91], v69 offset:4544
    s_lshl_b32 s42, s6, 5
    s_add_u32 s42, s42, 4096
    v_lshrrev_b32 v232, 1, v0
    v_lshl_add_u32 v232, v232, 14, s42
    v_and_b32 v233, 1, v0
    v_lshl_add_u32 v232, v233, 4, v232
    v_add_u32 v30, 0x1000, v232
    s_lshl_b32 s42, s7, 12
    s_add_u32 s42, s42, 0x280000
    v_lshl_add_u32 v233, v65, 4, s42
    v_min_u32 v31, 47, v65
    v_lshrrev_b32 v31, 3, v31
    v_and_b32 v236, 7, v0
    v_mul_u32_u24 v234, 12288, v236
    v_lshl_add_u32 v234, v31, 11, v234
    s_lshl_b32 s42, s6, 3
    s_add_u32 s42, s42, 0x2a0000
    v_add_u32 v234, s42, v234
    v_and_b32 v235, 127, v0
    s_lshl_b32 s51, s70, 11
    s_lshl_b32 s48, s66, 9
    s_add_u32 s51, s51, s48
    v_lshl_add_u32 v235, v235, 2, s51
    s_bfe_u32 s42, s2, 0x30003
    s_lshl_b32 s42, s42, 7
    v_lshl_add_u32 v237, v236, 10, s42
    s_and_b32 s42, s2, 7
    s_lshl_b32 s42, s42, 10
    v_lshl_add_u32 v236, v236, 7, s42
    s_add_u32 s44, s38, 0x2a1800
    s_addc_u32 s45, s39, 0
    s_mov_b32 s46, 0x18000
    s_mov_b32 s47, 0x20000
    v_mov_b32 v60, 0
    s_waitcnt lgkmcnt(4)
    v_mfma_f32_16x16x32_f16 v[140:143], v[112:115], v[96:99], 0
    v_mfma_f32_16x16x32_f16 v[140:143], v[116:119], v[100:103], v[140:143]
    v_mfma_f32_16x16x32_f16 v[140:143], v[120:123], v[104:107], v[140:143]
    v_mfma_f32_16x16x32_f16 v[140:143], v[124:127], v[108:111], v[140:143]
    s_waitcnt lgkmcnt(0)
    v_mfma_f32_16x16x32_f16 v[144:147], v[76:79], v[96:99], 0
    v_mfma_f32_16x16x32_f16 v[144:147], v[80:83], v[100:103], v[144:147]
    v_mfma_f32_16x16x32_f16 v[144:147], v[84:87], v[104:107], v[144:147]
    v_mfma_f32_16x16x32_f16 v[144:147], v[88:91], v[108:111], v[144:147]
    ds_write_b32 v64, v60 offset:3072
    v_mul_f32 v136, v136, v7
    v_mul_f32 v137, v137, v7
    v_mul_f32 v138, v138, v7
    v_mul_f32 v139, v139, v7
    v_mul_f32 v140, v140, v7
    v_mul_f32 v141, v141, v7
    v_mul_f32 v142, v142, v7
    v_mul_f32 v143, v143, v7
    v_mul_f32 v144, v144, v7
    v_mul_f32 v145, v145, v7
    v_mul_f32 v146, v146, v7
    v_mul_f32 v147, v147, v7
    ds_write_b128 v72, v[136:139]
    ds_write_b64 v73, v[140:141] offset:1024
    ds_write_b64 v74, v[142:143] offset:1032
    ds_write_b32 v75, v144 offset:2048
    ds_write_b32 v75, v145 offset:2112
    ds_write_b32 v75, v146 offset:2176
    ds_write_b32 v75, v147 offset:2240
    s_cmp_ge_u32 s2, 192
    s_cbranch_scc1 P0_M
    s_waitcnt vmcnt(6)
    v_lshlrev_b32 v240, 16, v168
    v_and_b32 v241, 0xffff0000, v168
    v_lshlrev_b32 v242, 16, v169
    v_and_b32 v243, 0xffff0000, v169
    v_mul_f32 v244, s54, -v240
    v_mul_f32 v245, s54, -v241
    v_mul_f32 v246, s54, -v242
    v_mul_f32 v247, s54, -v243
    v_exp_f32 v244, v244
    v_exp_f32 v245, v245
    v_exp_f32 v246, v246
    v_exp_f32 v247, v247
    v_add_f32 v244, 1.0, v244
    v_add_f32 v245, 1.0, v245
    v_add_f32 v246, 1.0, v246
    v_add_f32 v247, 1.0, v247
    v_rcp_f32 v244, v244
    v_rcp_f32 v245, v245
    v_rcp_f32 v246, v246
    v_rcp_f32 v247, v247
    v_mul_f32 v240, v240, v244
    v_mul_f32 v241, v241, v245
    v_mul_f32 v242, v242, v246
    v_mul_f32 v243, v243, v247
    v_cvt_pk_bf16_f32 v244, v240, v241
    v_lshlrev_b32 v240, 16, v244
    v_and_b32 v241, 0xffff0000, v244
    v_cvt_pk_bf16_f32 v245, v242, v243
    v_lshlrev_b32 v242, 16, v245
    v_and_b32 v243, 0xffff0000, v245
    s_waitcnt vmcnt(5)
    v_lshlrev_b32 v244, 16, v176
    v_and_b32 v245, 0xffff0000, v176
    v_lshlrev_b32 v246, 16, v177
    v_and_b32 v247, 0xffff0000, v177
    v_lshlrev_b32 v248, 16, v178
    v_and_b32 v249, 0xffff0000, v178
    v_lshlrev_b32 v250, 16, v179
    v_and_b32 v251, 0xffff0000, v179
    v_pk_mul_f32 v[192:193], v[240:241], v[244:245] op_sel:[0,0] op_sel_hi:[0,1]
    v_pk_mul_f32 v[194:195], v[240:241], v[246:247] op_sel:[0,0] op_sel_hi:[0,1]
    v_pk_mul_f32 v[196:197], v[240:241], v[248:249] op_sel:[0,0] op_sel_hi:[0,1]
    v_pk_mul_f32 v[198:199], v[240:241], v[250:251] op_sel:[0,0] op_sel_hi:[0,1]
    s_waitcnt vmcnt(4)
    v_lshlrev_b32 v244, 16, v180
    v_and_b32 v245, 0xffff0000, v180
    v_lshlrev_b32 v246, 16, v181
    v_and_b32 v247, 0xffff0000, v181
    v_lshlrev_b32 v248, 16, v182
    v_and_b32 v249, 0xffff0000, v182
    v_lshlrev_b32 v250, 16, v183
    v_and_b32 v251, 0xffff0000, v183
    v_pk_fma_f32 v[192:193], v[240:241], v[244:245], v[192:193] op_sel:[1,0,0] op_sel_hi:[1,1,1]
    v_pk_fma_f32 v[194:195], v[240:241], v[246:247], v[194:195] op_sel:[1,0,0] op_sel_hi:[1,1,1]
    v_pk_fma_f32 v[196:197], v[240:241], v[248:249], v[196:197] op_sel:[1,0,0] op_sel_hi:[1,1,1]
    v_pk_fma_f32 v[198:199], v[240:241], v[250:251], v[198:199] op_sel:[1,0,0] op_sel_hi:[1,1,1]
    s_waitcnt vmcnt(3)
    v_lshlrev_b32 v244, 16, v184
    v_and_b32 v245, 0xffff0000, v184
    v_lshlrev_b32 v246, 16, v185
    v_and_b32 v247, 0xffff0000, v185
    v_lshlrev_b32 v248, 16, v186
    v_and_b32 v249, 0xffff0000, v186
    v_lshlrev_b32 v250, 16, v187
    v_and_b32 v251, 0xffff0000, v187
    v_pk_fma_f32 v[192:193], v[242:243], v[244:245], v[192:193] op_sel:[0,0,0] op_sel_hi:[0,1,1]
    v_pk_fma_f32 v[194:195], v[242:243], v[246:247], v[194:195] op_sel:[0,0,0] op_sel_hi:[0,1,1]
    v_pk_fma_f32 v[196:197], v[242:243], v[248:249], v[196:197] op_sel:[0,0,0] op_sel_hi:[0,1,1]
    v_pk_fma_f32 v[198:199], v[242:243], v[250:251], v[198:199] op_sel:[0,0,0] op_sel_hi:[0,1,1]
    s_waitcnt vmcnt(2)
    v_lshlrev_b32 v244, 16, v188
    v_and_b32 v245, 0xffff0000, v188
    v_lshlrev_b32 v246, 16, v189
    v_and_b32 v247, 0xffff0000, v189
    v_lshlrev_b32 v248, 16, v190
    v_and_b32 v249, 0xffff0000, v190
    v_lshlrev_b32 v250, 16, v191
    v_and_b32 v251, 0xffff0000, v191
    v_pk_fma_f32 v[192:193], v[242:243], v[244:245], v[192:193] op_sel:[1,0,0] op_sel_hi:[1,1,1]
    v_pk_fma_f32 v[194:195], v[242:243], v[246:247], v[194:195] op_sel:[1,0,0] op_sel_hi:[1,1,1]
    v_pk_fma_f32 v[196:197], v[242:243], v[248:249], v[196:197] op_sel:[1,0,0] op_sel_hi:[1,1,1]
    v_pk_fma_f32 v[198:199], v[242:243], v[250:251], v[198:199] op_sel:[1,0,0] op_sel_hi:[1,1,1]
    v_permlane32_swap_b32 v192, v193
    v_permlane32_swap_b32 v194, v195
    v_permlane32_swap_b32 v196, v197
    v_permlane32_swap_b32 v198, v199
    v_add_f32 v192, v192, v193
    v_add_f32 v194, v194, v195
    v_add_f32 v196, v196, v197
    v_add_f32 v198, v198, v199
    v_permlane16_swap_b32 v192, v194
    s_nop 0
    v_permlane16_swap_b32 v196, v198
    v_add_f32 v192, v192, v194
    v_add_f32 v196, v196, v198
    ds_write2_b32 v165, v192, v196 offset0:0 offset1:4
P0_M:
    s_waitcnt lgkmcnt(0)
    s_barrier
    ds_read_b64_tr_b16 v[128:129], v17 offset:0
    ds_read_b64_tr_b16 v[130:131], v17 offset:4608
    ds_read_b64_tr_b16 v[132:133], v17 offset:128
    ds_read_b64_tr_b16 v[134:135], v17 offset:4736
    ds_read_b128 v[176:179], v167 offset:0
    ds_read_b128 v[180:183], v167 offset:512
    ds_read_b128 v[184:187], v167 offset:1024
    ds_read_b128 v[188:191], v167 offset:1536
    ds_read2st64_b32 v[80:81], v148 offset0:0 offset1:34
    ds_read2st64_b32 v[82:83], v149 offset0:0 offset1:34
    ds_read2st64_b32 v[84:85], v150 offset0:0 offset1:34
    ds_read2st64_b32 v[86:87], v151 offset0:0 offset1:34
    ds_read2st64_b32 v[88:89], v152 offset0:0 offset1:34
    ds_read2st64_b32 v[90:91], v153 offset0:0 offset1:34
    ds_read2st64_b32 v[92:93], v154 offset0:0 offset1:34
    ds_read2st64_b32 v[94:95], v155 offset0:0 offset1:34
    ds_read2st64_b32 v[96:97], v156 offset0:0 offset1:34
    ds_read2st64_b32 v[98:99], v157 offset0:0 offset1:34
    ds_read2st64_b32 v[100:101], v158 offset0:0 offset1:34
    s_waitcnt lgkmcnt(11)
    global_store_dwordx4 v8, v[128:131], s[38:39] sc1
    global_store_dwordx4 v8, v[132:135], s[38:39] offset:1024 sc1
    v_pk_add_f32 v[176:177], v[176:177], v[184:185]
    v_pk_add_f32 v[178:179], v[178:179], v[186:187]
    v_pk_add_f32 v[180:181], v[180:181], v[188:189]
    v_pk_add_f32 v[182:183], v[182:183], v[190:191]
    v_pk_add_f32 v[176:177], v[176:177], v[180:181]
    v_pk_add_f32 v[178:179], v[178:179], v[182:183]
    s_mov_b64 exec, 0xff
    s_cbranch_scc1 P0_M2
    global_store_dwordx4 v166, v[176:179], s[38:39] sc1
P0_M2:
    s_cmp_lg_u32 s7, 0
    s_cbranch_scc1 P0_M3
    s_mov_b64 exec, 0xff
    global_load_dword v38, v37, s[36:37] offset:128 sc1
P0_M3:
    s_mov_b64 exec, -1
    ds_read2st64_b32 v[102:103], v148 offset0:68 offset1:102
    ds_read2st64_b32 v[104:105], v149 offset0:68 offset1:102
    ds_read2st64_b32 v[106:107], v150 offset0:68 offset1:102
    ds_read2st64_b32 v[108:109], v151 offset0:68 offset1:102
    ds_read2st64_b32 v[110:111], v152 offset0:68 offset1:102
    ds_read2st64_b32 v[112:113], v153 offset0:68 offset1:102
    ds_read2st64_b32 v[114:115], v154 offset0:68 offset1:102
    ds_read2st64_b32 v[116:117], v155 offset0:68 offset1:102
    ds_read2st64_b32 v[118:119], v156 offset0:68 offset1:102
    ds_read2st64_b32 v[120:121], v157 offset0:68 offset1:102
    ds_read2st64_b32 v[122:123], v158 offset0:68 offset1:102
    v_and_b32 v6, 3, v0
    v_mul_u32_u24 v6, 4640, v6
    v_bfe_u32 v7, v0, 2, 2
    v_lshlrev_b32 v7, 7, v7
    v_sub_u32 v6, v6, v7
    v_lshl_add_u32 v6, v68, 4, v6
    s_mul_i32 s48, s70, 18560
    s_lshl_b32 s49, s71, 8
    s_sub_u32 s48, s48, s49
    s_add_u32 s48, s48, 35456
    v_add_u32 v6, s48, v6
    v_lshlrev_b32 v7, 3, v67
    v_lshl_add_u32 v7, v68, 4, v7
    s_mul_i32 s48, s70, 4224
    s_sub_u32 s48, s48, s49
    s_add_u32 s48, s48, 72200
    v_add_u32 v7, s48, v7
    v_lshlrev_b32 v2, 4, v0
    v_add_u32 v2, 34816, v2
    v_lshlrev_b32 v3, 4, v65
    s_lshl_b32 s51, s67, 16
    s_lshl_b32 s48, s66, 12
    s_add_u32 s51, s51, s48
    s_lshl_b32 s48, s7, 10
    s_add_u32 s51, s51, s48
    s_add_u32 s51, s51, 0xa80000
    v_add_u32 v76, s51, v3
    s_lshl_b32 s51, s7, 9
    s_add_u32 s51, s51, 83456
    v_lshl_add_u32 v77, v67, 2, s51
    v_lshl_add_u32 v77, v70, 7, v77
    v_lshl_add_u32 v77, v71, 6, v77
    s_mov_b32 s51, 82432
    v_lshl_add_u32 v79, v0, 2, s51
    s_lshl_b32 s51, s7, 7
    s_add_u32 s51, s51, 82432
    v_lshl_add_u32 v78, v68, 5, s51
    s_lshl_b32 s51, s7, 12
    s_add_u32 s51, s51, 85504
    v_xor_b32 v69, v65, v68
    v_lshl_add_u32 v69, v69, 4, s51
    v_bfe_u32 v140, v0, 2, 2
    v_lshlrev_b32 v140, 4, v140
    v_lshl_add_u32 v140, v65, 6, v140
    v_add_u32 v140, s51, v140
    v_xor_b32 v141, 16, v140
    v_xor_b32 v142, 32, v140
    v_xor_b32 v143, 48, v140
    s_mov_b32 s56, s38
    s_mov_b32 s57, s39
    s_mov_b32 s58, s69
    s_mov_b32 s59, 0x20000
    s_waitcnt lgkmcnt(11)
    v_add_f32 v80, v80, v81
    v_add_f32 v82, v82, v83
    v_add_f32 v84, v84, v85
    v_add_f32 v86, v86, v87
    v_add_f32 v88, v88, v89
    v_add_f32 v90, v90, v91
    v_add_f32 v92, v92, v93
    v_add_f32 v94, v94, v95
    v_add_f32 v96, v96, v97
    v_add_f32 v98, v98, v99
    v_add_f32 v100, v100, v101
    v_cvt_pk_bf16_f32 v40, v80, v82
    v_cvt_pk_bf16_f32 v41, v84, v86
    v_cvt_pk_bf16_f32 v42, v88, v90
    v_cvt_pk_bf16_f32 v43, v92, v94
    ds_write_b128 v2, v[40:43] offset:13920
    v_cvt_pk_bf16_f32 v44, v82, v84
    v_cvt_pk_bf16_f32 v45, v86, v88
    v_cvt_pk_bf16_f32 v46, v90, v92
    v_cvt_pk_bf16_f32 v47, v94, v96
    ds_write_b128 v2, v[44:47] offset:9280
    v_cvt_pk_bf16_f32 v48, v84, v86
    v_cvt_pk_bf16_f32 v49, v88, v90
    v_cvt_pk_bf16_f32 v50, v92, v94
    v_cvt_pk_bf16_f32 v51, v96, v98
    ds_write_b128 v2, v[48:51] offset:4640
    v_cvt_pk_bf16_f32 v52, v86, v88
    v_cvt_pk_bf16_f32 v53, v90, v92
    v_cvt_pk_bf16_f32 v54, v94, v96
    v_cvt_pk_bf16_f32 v55, v98, v100
    ds_write_b128 v2, v[52:55] offset:0
    s_waitcnt vmcnt(0)
    s_barrier
    s_cmp_lg_u32 s7, 0
    s_cbranch_scc1 P0_A1
    s_mov_b32 s3, 0
    s_mov_b64 exec, 0xff
P0_rdy:
    v_cmp_eq_u32 vcc, 0, v38
    s_add_u32 s3, s3, 1
    s_cmp_ge_u32 s3, 0x40000
    s_cbranch_vccz P0_rdy2
    s_cbranch_scc1 P0_rdy2
    s_mov_b64 exec, 0xff
    global_load_dword v38, v37, s[36:37] offset:128 sc1
    s_waitcnt vmcnt(0)
    s_branch P0_rdy
P0_rdy2:
    s_mov_b64 exec, 0xff
    v_add_u32 v238, 0x298000, v237
    global_atomic_add v238, v159, s[38:39] sc1
    s_mov_b64 exec, -1
P0_A1:
    s_waitcnt lgkmcnt(4)
    v_add_f32 v102, v102, v103
    v_add_f32 v104, v104, v105
    v_add_f32 v106, v106, v107
    v_add_f32 v108, v108, v109
    v_add_f32 v110, v110, v111
    v_add_f32 v112, v112, v113
    v_add_f32 v114, v114, v115
    v_add_f32 v116, v116, v117
    v_add_f32 v118, v118, v119
    v_add_f32 v120, v120, v121
    v_add_f32 v122, v122, v123
    v_cvt_pk_bf16_f32 v40, v102, v104
    v_cvt_pk_bf16_f32 v41, v106, v108
    v_cvt_pk_bf16_f32 v42, v110, v112
    v_cvt_pk_bf16_f32 v43, v114, v116
    ds_write_b128 v2, v[40:43] offset:32480
    v_cvt_pk_bf16_f32 v44, v104, v106
    v_cvt_pk_bf16_f32 v45, v108, v110
    v_cvt_pk_bf16_f32 v46, v112, v114
    v_cvt_pk_bf16_f32 v47, v116, v118
    ds_write_b128 v2, v[44:47] offset:27840
    v_cvt_pk_bf16_f32 v48, v106, v108
    v_cvt_pk_bf16_f32 v49, v110, v112
    v_cvt_pk_bf16_f32 v50, v114, v116
    v_cvt_pk_bf16_f32 v51, v118, v120
    ds_write_b128 v2, v[48:51] offset:23200
    v_cvt_pk_bf16_f32 v52, v108, v110
    v_cvt_pk_bf16_f32 v53, v112, v114
    v_cvt_pk_bf16_f32 v54, v116, v118
    v_cvt_pk_bf16_f32 v55, v120, v122
    ds_write_b128 v2, v[52:55] offset:18560
    v_mul_u32_u24 v124, 528, v68
    v_and_b32 v125, 12, v0
    v_add3_u32 v124, v124, v125, s41
    s_mov_b32 s21, s41
    v_and_b32 v125, 1, v0
    v_lshl_add_u32 v124, v125, 1, v124
    v_bfe_u32 v125, v0, 1, 1
    v_mul_u32_u24 v125, 2112, v125
    v_add_u32 v124, v124, v125
    v_xor_b32 v125, 16, v124
    v_xor_b32 v126, 32, v124
    v_xor_b32 v127, 48, v124
    v_mov_b32 v200, 0
    v_mov_b32 v201, 0
    v_mov_b32 v202, 0
    v_mov_b32 v203, 0
    v_mov_b32 v204, 0
    v_mov_b32 v205, 0
    v_mov_b32 v206, 0
    v_mov_b32 v207, 0
    v_mov_b32 v208, 0
    v_mov_b32 v209, 0
    v_mov_b32 v210, 0
    v_mov_b32 v211, 0
    v_mov_b32 v212, 0
    v_mov_b32 v213, 0
    v_mov_b32 v214, 0
    v_mov_b32 v215, 0
    v_mov_b32 v216, 0
    v_mov_b32 v217, 0
    v_mov_b32 v218, 0
    v_mov_b32 v219, 0
    v_mov_b32 v220, 0
    v_mov_b32 v221, 0
    v_mov_b32 v222, 0
    v_mov_b32 v223, 0
    v_mov_b32 v224, 0
    v_mov_b32 v225, 0
    v_mov_b32 v226, 0
    v_mov_b32 v227, 0
    v_mov_b32 v228, 0
    v_mov_b32 v229, 0
    v_mov_b32 v230, 0
    v_mov_b32 v231, 0
    v_cmp_eq_u32 vcc, 1, v31
    v_cmp_eq_u32 s[48:49], 4, v31
    s_nop 0
    s_or_b64 vcc, vcc, s[48:49]
    v_cndmask_b32 v65, 0, 1.0, vcc
    s_lshl_b32 s48, s6, 3
    s_add_u32 s48, s48, 0x288000
    v_lshl_add_u32 v64, v31, 11, s48
    s_lshl_b32 s48, s68, 16
    s_and_b32 s49, s68, 0xffff0000
    v_mov_b32 v66, s48
    v_mov_b32 v67, s49
    s_cmp_eq_u32 s70, 1
    s_cselect_b32 s54, 1.0, 0
    s_cmp_ge_u32 s22, 172
    s_cbranch_scc1 P0_D4
    s_and_b32 s40, s22, 3
    s_mul_i32 s40, s40, 352256
    s_lshr_b32 s41, s22, 2
    s_lshl_b32 s41, s41, 11
    s_add_u32 s41, s41, s40
    s_add_u32 s41, s41, 0xe00000
    v_mul_u32_u24 v144, 88064, v68
    v_and_b32 v145, 15, v0
    v_lshl_add_u32 v144, v145, 4, v144
    v_add_u32 v144, s41, v144
    s_add_u32 s41, s23, 4096
    v_lshrrev_b32 v161, 2, v3
    v_add_u32 v161, s41, v161
    v_add_u32 v162, 8192, v161
    v_add_u32 v163, 16384, v161
    v_add_u32 v164, 24576, v161
    global_load_dword v168, v161, s[28:29] offset:-4096
    global_load_dword v169, v161, s[28:29] offset:-3072
    global_load_dword v170, v161, s[28:29] offset:-2048
    global_load_dword v171, v161, s[28:29] offset:-1024
    global_load_dword v172, v161, s[28:29] offset:0
    global_load_dword v173, v161, s[28:29] offset:1024
    global_load_dword v174, v161, s[28:29] offset:2048
    global_load_dword v175, v161, s[28:29] offset:3072
    global_load_dword v176, v162, s[28:29] offset:-4096
    global_load_dword v177, v162, s[28:29] offset:-3072
    global_load_dword v178, v162, s[28:29] offset:-2048
    global_load_dword v179, v162, s[28:29] offset:-1024
    global_load_dword v180, v162, s[28:29] offset:0
    global_load_dword v181, v162, s[28:29] offset:1024
    global_load_dword v182, v162, s[28:29] offset:2048
    global_load_dword v183, v162, s[28:29] offset:3072
    global_load_dword v184, v163, s[28:29] offset:-4096
    global_load_dword v185, v163, s[28:29] offset:-3072
    global_load_dword v186, v163, s[28:29] offset:-2048
    global_load_dword v187, v163, s[28:29] offset:-1024
    global_load_dword v188, v163, s[28:29] offset:0
    global_load_dword v189, v163, s[28:29] offset:1024
    global_load_dword v190, v163, s[28:29] offset:2048
    global_load_dword v191, v163, s[28:29] offset:3072
    global_load_dword v192, v164, s[28:29] offset:-4096
    global_load_dword v193, v164, s[28:29] offset:-3072
    global_load_dword v194, v164, s[28:29] offset:-2048
    global_load_dword v195, v164, s[28:29] offset:-1024
    global_load_dword v196, v164, s[28:29] offset:0
    global_load_dword v197, v164, s[28:29] offset:1024
    global_load_dword v198, v164, s[28:29] offset:2048
    global_load_dword v199, v164, s[28:29] offset:3072
    s_waitcnt vmcnt(0) lgkmcnt(0)
    v_perm_b32 v200, v169, v168, s52
    v_perm_b32 v201, v171, v170, s52
    v_perm_b32 v202, v173, v172, s52
    v_perm_b32 v203, v175, v174, s52
    global_store_dwordx4 v144, v[200:203], s[38:39] offset:0 sc1
    v_perm_b32 v204, v169, v168, s53
    v_perm_b32 v205, v171, v170, s53
    v_perm_b32 v206, v173, v172, s53
    v_perm_b32 v207, v175, v174, s53
    global_store_dwordx4 v144, v[204:207], s[38:39] offset:256 sc1
    v_perm_b32 v208, v177, v176, s52
    v_perm_b32 v209, v179, v178, s52
    v_perm_b32 v210, v181, v180, s52
    v_perm_b32 v211, v183, v182, s52
    global_store_dwordx4 v144, v[208:211], s[38:39] offset:512 sc1
    v_perm_b32 v212, v177, v176, s53
    v_perm_b32 v213, v179, v178, s53
    v_perm_b32 v214, v181, v180, s53
    v_perm_b32 v215, v183, v182, s53
    global_store_dwordx4 v144, v[212:215], s[38:39] offset:768 sc1
    v_perm_b32 v216, v185, v184, s52
    v_perm_b32 v217, v187, v186, s52
    v_perm_b32 v218, v189, v188, s52
    v_perm_b32 v219, v191, v190, s52
    global_store_dwordx4 v144, v[216:219], s[38:39] offset:1024 sc1
    v_perm_b32 v220, v185, v184, s53
    v_perm_b32 v221, v187, v186, s53
    v_perm_b32 v222, v189, v188, s53
    v_perm_b32 v223, v191, v190, s53
    global_store_dwordx4 v144, v[220:223], s[38:39] offset:1280 sc1
    v_perm_b32 v224, v193, v192, s52
    v_perm_b32 v225, v195, v194, s52
    v_perm_b32 v226, v197, v196, s52
    v_perm_b32 v227, v199, v198, s52
    global_store_dwordx4 v144, v[224:227], s[38:39] offset:1536 sc1
    v_perm_b32 v228, v193, v192, s53
    v_perm_b32 v229, v195, v194, s53
    v_perm_b32 v230, v197, v196, s53
    v_perm_b32 v231, v199, v198, s53
    global_store_dwordx4 v144, v[228:231], s[38:39] offset:1792 sc1
P0_D4:
    s_cmp_lg_u32 s7, 0
    s_cbranch_scc1 P0_go
    v_add_u32 v238, 0x298000, v236
    s_bfe_u32 s4, s2, 0x30003
    s_lshl_b32 s4, 1, s4
    s_xor_b32 s5, s4, 0xff
    s_mov_b32 exec_hi, 0
    s_mov_b32 exec_lo, s4
    s_mov_b32 s3, 0
P0_poll:
    global_load_dword v239, v238, s[38:39] sc1
    s_add_u32 s3, s3, 1
    s_cmp_ge_u32 s3, 0x40000
    s_cbranch_scc1 P0_go
    s_waitcnt vmcnt(0)
    v_cmp_ne_u32 vcc, 32, v239
    s_nop 0
    s_and_b32 s4, vcc_lo, 0xff
    s_cselect_b32 s4, s4, s5
    s_cselect_b32 s5, s5, 0
    s_cmp_eq_u32 s4, 0
    s_cbranch_scc1 P0_go
    s_mov_b32 exec_lo, s4
    s_branch P0_poll
P0_go:
    s_mov_b64 exec, -1
    s_barrier
    global_load_dwordx4 v[80:83], v233, s[38:39] offset:0 sc1
    global_load_dwordx4 v[84:87], v233, s[38:39] offset:1024 sc1
    global_load_dwordx4 v[88:91], v233, s[38:39] offset:2048 sc1
    global_load_dwordx4 v[92:95], v233, s[38:39] offset:3072 sc1
    global_load_dwordx2 v[72:73], v234, s[38:39] sc1
    global_load_dwordx4 v[96:99], v232, s[38:39] offset:-4096 sc1
    global_load_dwordx4 v[100:103], v30, s[38:39] sc1
    s_mov_b32 s52, 0
    buffer_load_dword v160, v235, s[44:47], s52 offen sc1
    s_mov_b32 s52, 12288
    buffer_load_dword v161, v235, s[44:47], s52 offen sc1
    s_mov_b32 s52, 24576
    buffer_load_dword v162, v235, s[44:47], s52 offen sc1
    s_mov_b32 s52, 36864
    buffer_load_dword v163, v235, s[44:47], s52 offen sc1
    s_mov_b32 s52, 49152
    buffer_load_dword v164, v235, s[44:47], s52 offen sc1
    s_mov_b32 s52, 61440
    buffer_load_dword v165, v235, s[44:47], s52 offen sc1
    s_mov_b32 s52, 73728
    buffer_load_dword v166, v235, s[44:47], s52 offen sc1
    s_mov_b32 s52, 86016
    buffer_load_dword v167, v235, s[44:47], s52 offen sc1
    s_min_u32 s50, s69, 1409024
    s_mov_b32 s51, 0x20000
    s_mov_b32 s48, s24
    s_mov_b32 s49, s25
    s_add_u32 m0, s21, 0
    s_nop 0
    buffer_load_dwordx4 v10, s[48:51], 0 offen lds
    s_add_u32 m0, s21, 1024
    s_nop 0
    buffer_load_dwordx4 v11, s[48:51], 0 offen lds
    s_mov_b32 s48, s26
    s_mov_b32 s49, s27
    s_add_u32 m0, s21, 2112
    s_nop 0
    buffer_load_dwordx4 v10, s[48:51], 0 offen lds
    s_add_u32 m0, s21, 3136
    s_nop 0
    buffer_load_dwordx4 v11, s[48:51], 0 offen lds
    s_waitcnt vmcnt(18)
    ds_write_b128 v69, v[80:83] offset:0
    s_waitcnt vmcnt(17)
    ds_write_b128 v69, v[84:87] offset:1024
    s_waitcnt vmcnt(16)
    ds_write_b128 v69, v[88:91] offset:2048
    s_waitcnt vmcnt(15)
    ds_write_b128 v69, v[92:95] offset:3072
    ds_read_b128 v[16:19], v140
    ds_read_b128 v[20:23], v141
    ds_read_b128 v[24:27], v142
    ds_read_b128 v[28:31], v143
    s_waitcnt vmcnt(14)
    v_add_f32_dpp v72, v72, v72 row_shr:1 row_mask:0xf bank_mask:0xf
    v_add_f32_dpp v73, v73, v73 row_shr:1 row_mask:0xf bank_mask:0xf
    s_nop 0
    v_add_f32_dpp v72, v72, v72 row_shr:2 row_mask:0xf bank_mask:0xf
    v_add_f32_dpp v73, v73, v73 row_shr:2 row_mask:0xf bank_mask:0xf
    s_nop 0
    v_add_f32_dpp v72, v72, v72 row_shr:4 row_mask:0xf bank_mask:0xf
    v_add_f32_dpp v73, v73, v73 row_shr:4 row_mask:0xf bank_mask:0xf
    v_cvt_pk_bf16_f32 v73, v72, v73
    v_lshlrev_b32 v72, 16, v73
    v_and_b32 v73, 0xffff0000, v73
    v_add_f32 v72, v72, v65
    v_add_f32 v73, v73, v65
    v_cvt_pk_bf16_f32 v73, v72, v73
    v_lshlrev_b32 v72, 16, v73
    v_and_b32 v73, 0xffff0000, v73
    v_readlane_b32 s60, v72, 7
    v_readlane_b32 s61, v73, 7
    v_readlane_b32 s62, v72, 15
    v_readlane_b32 s63, v73, 15
    v_readlane_b32 s64, v72, 23
    v_readlane_b32 s65, v73, 23
    s_mov_b32 vcc_lo, 0x55555555
    s_mov_b32 vcc_hi, 0x55555555
    v_mov_b32 v74, s60
    v_mov_b32 v75, s61
    v_mul_f32 v66, s64, v66
    v_mul_f32 v67, s65, v67
    s_waitcnt vmcnt(12)
    v_cndmask_b32_dpp v8, v100, v96, vcc quad_perm:[1,0,3,2] row_mask:0xf bank_mask:0xf
    v_cndmask_b32_dpp v9, v101, v97, vcc quad_perm:[1,0,3,2] row_mask:0xf bank_mask:0xf
    v_cndmask_b32_dpp v10, v102, v98, vcc quad_perm:[1,0,3,2] row_mask:0xf bank_mask:0xf
    v_cndmask_b32_dpp v11, v103, v99, vcc quad_perm:[1,0,3,2] row_mask:0xf bank_mask:0xf
    s_not_b64 vcc, vcc
    v_cndmask_b32_dpp v12, v96, v100, vcc quad_perm:[1,0,3,2] row_mask:0xf bank_mask:0xf
    v_cndmask_b32_dpp v13, v97, v101, vcc quad_perm:[1,0,3,2] row_mask:0xf bank_mask:0xf
    v_cndmask_b32_dpp v14, v98, v102, vcc quad_perm:[1,0,3,2] row_mask:0xf bank_mask:0xf
    v_cndmask_b32_dpp v15, v99, v103, vcc quad_perm:[1,0,3,2] row_mask:0xf bank_mask:0xf
    v_lshlrev_b32 v32, 16, v8
    v_and_b32 v33, 0xffff0000, v8
    v_lshlrev_b32 v34, 16, v9
    v_and_b32 v35, 0xffff0000, v9
    v_lshlrev_b32 v36, 16, v10
    v_and_b32 v37, 0xffff0000, v10
    v_lshlrev_b32 v38, 16, v11
    v_and_b32 v39, 0xffff0000, v11
    s_waitcnt lgkmcnt(0)
    v_fma_f32 v48, v32, v16, v17
    v_fma_f32 v49, v33, v18, v19
    v_fma_f32 v50, v34, v20, v21
    v_fma_f32 v51, v35, v22, v23
    v_fma_f32 v52, v36, v24, v25
    v_fma_f32 v53, v37, v26, v27
    v_fma_f32 v54, v38, v28, v29
    v_fma_f32 v55, v39, v30, v31
    v_fma_f32 v48, v48, s62, v74
    v_fma_f32 v49, v49, s62, v74
    v_fma_f32 v50, v50, s62, v74
    v_fma_f32 v51, v51, s62, v74
    v_fma_f32 v52, v52, s62, v74
    v_fma_f32 v53, v53, s62, v74
    v_fma_f32 v54, v54, s62, v74
    v_fma_f32 v55, v55, s62, v74
    v_cvt_pk_bf16_f32 v8, v48, v49
    v_cvt_pk_bf16_f32 v9, v50, v51
    v_cvt_pk_bf16_f32 v10, v52, v53
    v_cvt_pk_bf16_f32 v11, v54, v55
    ds_write_b128 v2, v[8:11] offset:37248
    v_lshlrev_b32 v40, 16, v12
    v_and_b32 v41, 0xffff0000, v12
    v_lshlrev_b32 v42, 16, v13
    v_and_b32 v43, 0xffff0000, v13
    v_lshlrev_b32 v44, 16, v14
    v_and_b32 v45, 0xffff0000, v14
    v_lshlrev_b32 v46, 16, v15
    v_and_b32 v47, 0xffff0000, v15
    v_fma_f32 v56, v40, v16, v17
    v_fma_f32 v57, v41, v18, v19
    v_fma_f32 v58, v42, v20, v21
    v_fma_f32 v59, v43, v22, v23
    v_fma_f32 v60, v44, v24, v25
    v_fma_f32 v61, v45, v26, v27
    v_fma_f32 v62, v46, v28, v29
    v_fma_f32 v63, v47, v30, v31
    v_fma_f32 v56, v56, s63, v75
    v_fma_f32 v57, v57, s63, v75
    v_fma_f32 v58, v58, s63, v75
    v_fma_f32 v59, v59, s63, v75
    v_fma_f32 v60, v60, s63, v75
    v_fma_f32 v61, v61, s63, v75
    v_fma_f32 v62, v62, s63, v75
    v_fma_f32 v63, v63, s63, v75
    v_cvt_pk_bf16_f32 v12, v56, v57
    v_cvt_pk_bf16_f32 v13, v58, v59
    v_cvt_pk_bf16_f32 v14, v60, v61
    v_cvt_pk_bf16_f32 v15, v62, v63
    ds_write_b128 v2, v[12:15] offset:41472
    s_waitcnt vmcnt(4)
    v_add_f32 v160, v160, v164
    v_add_f32 v161, v161, v165
    v_add_f32 v162, v162, v166
    v_add_f32 v163, v163, v167
    v_add_f32 v160, v160, v161
    v_add_f32 v162, v162, v163
    v_add_f32 v160, v160, v162
    v_cvt_pk_bf16_f32 v160, v160, v160
    v_lshlrev_b32 v160, 16, v160
    v_add_f32 v160, s54, v160
    v_cvt_pk_bf16_f32 v160, v160, v160
    v_lshlrev_b32 v160, 16, v160
    ds_write_b32 v79, v160
    s_waitcnt lgkmcnt(0)
    s_barrier
    ds_read_b128 a[0:3], v6 offset:3776
    ds_read_b64 a[60:61], v7 offset:3776
    ds_read_b64 a[62:63], v7 offset:3784
    ds_read_b128 a[4:7], v6 offset:3264
    ds_read_b64 a[56:57], v7 offset:3264
    ds_read_b64 a[58:59], v7 offset:3272
    ds_read_b128 a[8:11], v6 offset:2752
    ds_read_b64 a[52:53], v7 offset:2752
    ds_read_b64 a[54:55], v7 offset:2760
    ds_read_b128 a[12:15], v6 offset:2240
    ds_read_b64 a[48:49], v7 offset:2240
    ds_read_b64 a[50:51], v7 offset:2248
    ds_read_b128 a[16:19], v6 offset:1728
    ds_read_b64 a[44:45], v7 offset:1728
    ds_read_b64 a[46:47], v7 offset:1736
    ds_read_b128 a[20:23], v6 offset:1216
    ds_read_b64 a[40:41], v7 offset:1216
    ds_read_b64 a[42:43], v7 offset:1224
    ds_read_b128 a[24:27], v6 offset:704
    ds_read_b64 a[36:37], v7 offset:704
    ds_read_b64 a[38:39], v7 offset:712
    ds_read_b128 a[28:31], v6 offset:192
    ds_read_b64 a[32:33], v7 offset:192
    ds_read_b64 a[34:35], v7 offset:200
    s_mov_b32 exec_lo, 0
    s_mov_b32 exec_hi, 0x8000
    global_store_dwordx2 v64, v[72:73], s[38:39] sc1
    s_mov_b64 exec, -1
    v_fmac_f32 v32, v48, v66
    v_fmac_f32 v33, v49, v66
    v_fmac_f32 v34, v50, v66
    v_fmac_f32 v35, v51, v66
    v_fmac_f32 v36, v52, v66
    v_fmac_f32 v37, v53, v66
    v_fmac_f32 v38, v54, v66
    v_fmac_f32 v39, v55, v66
    v_fmac_f32 v40, v56, v67
    v_fmac_f32 v41, v57, v67
    v_fmac_f32 v42, v58, v67
    v_fmac_f32 v43, v59, v67
    v_fmac_f32 v44, v60, v67
    v_fmac_f32 v45, v61, v67
    v_fmac_f32 v46, v62, v67
    v_fmac_f32 v47, v63, v67
.p2align 3
    s_waitcnt lgkmcnt(15)
    s_nop 0
    v_mfma_f32_16x16x32_bf16 a[156:159], a[0:3], a[60:63], 0
    s_mov_b32 s48, 0
    s_waitcnt lgkmcnt(15)
    s_nop 0
    v_mfma_f32_16x16x32_bf16 a[152:155], a[0:3], a[56:59], 0
    s_mov_b32 s49, 16384
    v_mfma_f32_16x16x32_bf16 a[156:159], a[4:7], a[56:59], a[156:159]
    s_mov_b32 s50, 32768
    s_waitcnt lgkmcnt(15)
    s_nop 0
    v_mfma_f32_16x16x32_bf16 a[148:151], a[0:3], a[52:55], 0
    s_mov_b32 s51, 49152
    v_mfma_f32_16x16x32_bf16 a[152:155], a[4:7], a[52:55], a[152:155]
    s_lshl_b32 s40, s7, 13
    v_mfma_f32_16x16x32_bf16 a[156:159], a[8:11], a[52:55], a[156:159]
    v_add_u32 v3, s40, v3
    s_waitcnt lgkmcnt(12)
    s_nop 0
    v_mfma_f32_16x16x32_bf16 a[144:147], a[0:3], a[48:51], 0
    v_lshlrev_b32 v2, 5, v0
    v_mfma_f32_16x16x32_bf16 a[148:151], a[4:7], a[48:51], a[148:151]
    v_lshrrev_b32 v1, 3, v0
    v_mfma_f32_16x16x32_bf16 a[152:155], a[8:11], a[48:51], a[152:155]
    v_lshlrev_b32 v1, 16, v1
    v_mfma_f32_16x16x32_bf16 a[156:159], a[12:15], a[48:51], a[156:159]
    v_and_b32 v4, 7, v0
    s_waitcnt lgkmcnt(9)
    s_nop 0
    v_mfma_f32_16x16x32_bf16 a[140:143], a[0:3], a[44:47], 0
    ds_read_b128 a[64:67], v6 offset:3712
    v_lshl_add_u32 v1, v4, 4, v1
    v_mfma_f32_16x16x32_bf16 a[144:147], a[4:7], a[44:47], a[144:147]
    ds_read_b64 a[124:125], v7 offset:3712
    s_lshl_b32 s42, s6, 8
    v_mfma_f32_16x16x32_bf16 a[148:151], a[8:11], a[44:47], a[148:151]
    ds_read_b64 a[126:127], v7 offset:3720
    s_add_u32 s42, s42, 0x580000
    v_mfma_f32_16x16x32_bf16 a[152:155], a[12:15], a[44:47], a[152:155]
    ds_read_b128 a[68:71], v6 offset:3200
    v_add_u32 v1, s42, v1
    v_mfma_f32_16x16x32_bf16 a[156:159], a[16:19], a[44:47], a[156:159]
    ds_read_b64 a[120:121], v7 offset:3200
    s_lshl_b32 s40, s7, 7
    s_waitcnt lgkmcnt(11)
    s_nop 0
    v_mfma_f32_16x16x32_bf16 a[136:139], a[0:3], a[40:43], 0
    ds_read_b64 a[122:123], v7 offset:3208
    s_add_u32 s41, s40, 83456
    v_mfma_f32_16x16x32_bf16 a[140:143], a[4:7], a[40:43], a[140:143]
    ds_read_b128 a[72:75], v6 offset:2688
    v_lshl_add_u32 v5, v4, 4, s41
    v_mfma_f32_16x16x32_bf16 a[144:147], a[8:11], a[40:43], a[144:147]
    ds_read_b64 a[116:117], v7 offset:2688
    s_mul_i32 s43, s66, 22528
    v_mfma_f32_16x16x32_bf16 a[148:151], a[12:15], a[40:43], a[148:151]
    ds_read_b64 a[118:119], v7 offset:2696
    s_lshl_b32 s54, s67, 9
    v_mfma_f32_16x16x32_bf16 a[152:155], a[16:19], a[40:43], a[152:155]
    ds_read_b128 a[76:79], v6 offset:2176
    s_add_u32 s43, s43, s54
    v_mfma_f32_16x16x32_bf16 a[156:159], a[20:23], a[40:43], a[156:159]
    ds_read_b64 a[112:113], v7 offset:2176
    s_add_u32 s43, s43, s40
    s_waitcnt lgkmcnt(14)
    s_nop 0
    v_mfma_f32_16x16x32_bf16 a[132:135], a[0:3], a[36:39], 0
    ds_read_b64 a[114:115], v7 offset:2184
    s_add_u32 s43, s43, 0x2c0000
    v_mfma_f32_16x16x32_bf16 a[136:139], a[4:7], a[36:39], a[136:139]
    ds_read_b128 a[80:83], v6 offset:1664
    v_lshl_add_u32 v4, v4, 4, s43
    v_mfma_f32_16x16x32_bf16 a[140:143], a[8:11], a[36:39], a[140:143]
    ds_read_b64 a[108:109], v7 offset:1664
    v_mfma_f32_16x16x32_bf16 a[144:147], a[12:15], a[36:39], a[144:147]
    ds_read_b64 a[110:111], v7 offset:1672
    v_mfma_f32_16x16x32_bf16 a[148:151], a[16:19], a[36:39], a[148:151]
    ds_read_b128 a[84:87], v6 offset:1152
    v_mfma_f32_16x16x32_bf16 a[152:155], a[20:23], a[36:39], a[152:155]
    ds_read_b64 a[104:105], v7 offset:1152
    v_mfma_f32_16x16x32_bf16 a[156:159], a[24:27], a[36:39], a[156:159]
    ds_read_b64 a[106:107], v7 offset:1160
    s_waitcnt lgkmcnt(15)
    s_nop 0
    v_mfma_f32_16x16x32_bf16 a[128:131], a[0:3], a[32:35], 0
    ds_read_b128 a[88:91], v6 offset:640
    v_mfma_f32_16x16x32_bf16 a[132:135], a[4:7], a[32:35], a[132:135]
    ds_read_b64 a[100:101], v7 offset:640
    v_mfma_f32_16x16x32_bf16 a[136:139], a[8:11], a[32:35], a[136:139]
    ds_read_b64 a[102:103], v7 offset:648
    v_mfma_f32_16x16x32_bf16 a[140:143], a[12:15], a[32:35], a[140:143]
    ds_read_b128 a[92:95], v6 offset:128
    v_mfma_f32_16x16x32_bf16 a[144:147], a[16:19], a[32:35], a[144:147]
    ds_read_b64 a[96:97], v7 offset:128
    v_mfma_f32_16x16x32_bf16 a[148:151], a[20:23], a[32:35], a[148:151]
    ds_read_b64 a[98:99], v7 offset:136
    v_mfma_f32_16x16x32_bf16 a[152:155], a[24:27], a[32:35], a[152:155]
    ds_read_b128 v[168:171], v78 offset:0
    v_mfma_f32_16x16x32_bf16 a[156:159], a[28:31], a[32:35], a[156:159]
    ds_read_b128 v[172:175], v78 offset:16
    ds_read_b128 v[176:179], v78 offset:512
    ds_read_b128 v[180:183], v78 offset:528
    s_waitcnt lgkmcnt(0)
    s_nop 0
    v_mfma_f32_16x16x32_bf16 a[156:159], a[64:67], a[124:127], a[156:159]
    ds_read_b128 a[0:3], v6 offset:3648
    v_mfma_f32_16x16x32_bf16 a[152:155], a[64:67], a[120:123], a[152:155]
    ds_read_b64 a[60:61], v7 offset:3648
    v_mfma_f32_16x16x32_bf16 a[156:159], a[68:71], a[120:123], a[156:159]
    ds_read_b64 a[62:63], v7 offset:3656
    v_mfma_f32_16x16x32_bf16 a[148:151], a[64:67], a[116:119], a[148:151]
    ds_read_b128 a[4:7], v6 offset:3136
    v_mfma_f32_16x16x32_bf16 a[152:155], a[68:71], a[116:119], a[152:155]
    ds_read_b64 a[56:57], v7 offset:3136
    v_mfma_f32_16x16x32_bf16 a[156:159], a[72:75], a[116:119], a[156:159]
    ds_read_b64 a[58:59], v7 offset:3144
    v_mfma_f32_16x16x32_bf16 a[144:147], a[64:67], a[112:115], a[144:147]
    ds_read_b128 a[8:11], v6 offset:2624
    v_mfma_f32_16x16x32_bf16 a[148:151], a[68:71], a[112:115], a[148:151]
    ds_read_b64 a[52:53], v7 offset:2624
    v_mfma_f32_16x16x32_bf16 a[152:155], a[72:75], a[112:115], a[152:155]
    ds_read_b64 a[54:55], v7 offset:2632
    v_mfma_f32_16x16x32_bf16 a[156:159], a[76:79], a[112:115], a[156:159]
    ds_read_b128 a[12:15], v6 offset:2112
    v_mfma_f32_16x16x32_bf16 a[140:143], a[64:67], a[108:111], a[140:143]
    ds_read_b64 a[48:49], v7 offset:2112
    v_mfma_f32_16x16x32_bf16 a[144:147], a[68:71], a[108:111], a[144:147]
    ds_read_b64 a[50:51], v7 offset:2120
    v_mfma_f32_16x16x32_bf16 a[148:151], a[72:75], a[108:111], a[148:151]
    ds_read_b128 a[16:19], v6 offset:1600
    v_mfma_f32_16x16x32_bf16 a[152:155], a[76:79], a[108:111], a[152:155]
    ds_read_b64 a[44:45], v7 offset:1600
    v_mfma_f32_16x16x32_bf16 a[156:159], a[80:83], a[108:111], a[156:159]
    ds_read_b64 a[46:47], v7 offset:1608
    v_mfma_f32_16x16x32_bf16 a[136:139], a[64:67], a[104:107], a[136:139]
    ds_read_b128 a[20:23], v6 offset:1088
    v_mfma_f32_16x16x32_bf16 a[140:143], a[68:71], a[104:107], a[140:143]
    ds_read_b64 a[40:41], v7 offset:1088
    v_mfma_f32_16x16x32_bf16 a[144:147], a[72:75], a[104:107], a[144:147]
    ds_read_b64 a[42:43], v7 offset:1096
    v_mfma_f32_16x16x32_bf16 a[148:151], a[76:79], a[104:107], a[148:151]
    ds_read_b128 a[24:27], v6 offset:576
    v_mfma_f32_16x16x32_bf16 a[152:155], a[80:83], a[104:107], a[152:155]
    ds_read_b64 a[36:37], v7 offset:576
    s_waitcnt vmcnt(1)
    v_mfma_f32_16x16x32_bf16 a[156:159], a[84:87], a[104:107], a[156:159]
    ds_read_b64 a[38:39], v7 offset:584
    ds_read_u16_d16_hi v200, v124 offset:0
    ds_read_u16_d16_hi v201, v124 offset:64
    v_mfma_f32_16x16x32_bf16 a[132:135], a[64:67], a[100:103], a[132:135]
    ds_read_b128 a[28:31], v6 offset:64
    ds_read_u16_d16_hi v202, v124 offset:128
    ds_read_u16_d16_hi v203, v124 offset:192
    v_mfma_f32_16x16x32_bf16 a[136:139], a[68:71], a[100:103], a[136:139]
    ds_read_b64 a[32:33], v7 offset:64
    ds_read_u16_d16_hi v204, v124 offset:256
    ds_read_u16_d16_hi v205, v124 offset:320
    v_mfma_f32_16x16x32_bf16 a[140:143], a[72:75], a[100:103], a[140:143]
    ds_read_b64 a[34:35], v7 offset:72
    ds_read_u16_d16_hi v206, v124 offset:384
    ds_read_u16_d16_hi v207, v124 offset:448
    v_mfma_f32_16x16x32_bf16 a[144:147], a[76:79], a[100:103], a[144:147]
    ds_read_u16_d16_hi v208, v125 offset:0
    ds_read_u16_d16_hi v209, v125 offset:64
    v_mfma_f32_16x16x32_bf16 a[148:151], a[80:83], a[100:103], a[148:151]
    ds_read_u16_d16_hi v210, v125 offset:128
    ds_read_u16_d16_hi v211, v125 offset:192
    v_mfma_f32_16x16x32_bf16 a[152:155], a[84:87], a[100:103], a[152:155]
    ds_read_u16_d16_hi v212, v125 offset:256
    ds_read_u16_d16_hi v213, v125 offset:320
    v_mfma_f32_16x16x32_bf16 a[156:159], a[88:91], a[100:103], a[156:159]
    ds_read_u16_d16_hi v214, v125 offset:384
    ds_read_u16_d16_hi v215, v125 offset:448
    v_mfma_f32_16x16x32_bf16 a[128:131], a[64:67], a[96:99], a[128:131]
    ds_read_u16_d16_hi v216, v126 offset:0
    ds_read_u16_d16_hi v217, v126 offset:64
    v_mfma_f32_16x16x32_bf16 a[132:135], a[68:71], a[96:99], a[132:135]
    ds_read_u16_d16_hi v218, v126 offset:128
    ds_read_u16_d16_hi v219, v126 offset:192
    v_mfma_f32_16x16x32_bf16 a[136:139], a[72:75], a[96:99], a[136:139]
    ds_read_u16_d16_hi v220, v126 offset:256
    ds_read_u16_d16_hi v221, v126 offset:320
    v_mfma_f32_16x16x32_bf16 a[140:143], a[76:79], a[96:99], a[140:143]
    ds_read_u16_d16_hi v222, v126 offset:384
    ds_read_u16_d16_hi v223, v126 offset:448
    v_mfma_f32_16x16x32_bf16 a[144:147], a[80:83], a[96:99], a[144:147]
    ds_read_u16_d16_hi v224, v127 offset:0
    ds_read_u16_d16_hi v225, v127 offset:64
    v_mfma_f32_16x16x32_bf16 a[148:151], a[84:87], a[96:99], a[148:151]
    ds_read_u16_d16_hi v226, v127 offset:128
    ds_read_u16_d16_hi v227, v127 offset:192
    v_mfma_f32_16x16x32_bf16 a[152:155], a[88:91], a[96:99], a[152:155]
    ds_read_u16_d16_hi v228, v127 offset:256
    ds_read_u16_d16_hi v229, v127 offset:320
    v_mfma_f32_16x16x32_bf16 a[156:159], a[92:95], a[96:99], a[156:159]
    ds_read_u16_d16_hi v230, v127 offset:384
    ds_read_u16_d16_hi v231, v127 offset:448
    s_waitcnt lgkmcnt(0)
    s_nop 0
    v_mfma_f32_16x16x32_bf16 a[156:159], a[0:3], a[60:63], a[156:159]
    ds_read_b128 a[64:67], v6 offset:3584
    v_pk_mul_f32 v[184:185], v[176:177], v[200:201]
    v_mfma_f32_16x16x32_bf16 a[152:155], a[0:3], a[56:59], a[152:155]
    ds_read_b64 a[124:125], v7 offset:3584
    v_pk_mul_f32 v[186:187], v[178:179], v[202:203]
    v_mul_f32 v81, v168, v200
    v_mul_f32 v83, v168, v208
    v_mfma_f32_16x16x32_bf16 a[156:159], a[4:7], a[56:59], a[156:159]
    ds_read_b64 a[126:127], v7 offset:3592
    v_pk_mul_f32 v[188:189], v[180:181], v[204:205]
    v_mfma_f32_16x16x32_bf16 a[148:151], a[0:3], a[52:55], a[148:151]
    ds_read_b128 a[68:71], v6 offset:3072
    v_pk_mul_f32 v[190:191], v[182:183], v[206:207]
    v_mul_f32 v85, v168, v216
    v_mul_f32 v87, v168, v224
    v_mfma_f32_16x16x32_bf16 a[152:155], a[4:7], a[52:55], a[152:155]
    ds_read_b64 a[120:121], v7 offset:3072
    v_cvt_pk_bf16_f32 v96, v184, v185
    v_mfma_f32_16x16x32_bf16 a[156:159], a[8:11], a[52:55], a[156:159]
    ds_read_b64 a[122:123], v7 offset:3080
    v_cvt_pk_bf16_f32 v97, v186, v187
    v_fmac_f32 v81, v169, v201
    v_fmac_f32 v83, v169, v209
    v_mfma_f32_16x16x32_bf16 a[144:147], a[0:3], a[48:51], a[144:147]
    ds_read_b128 a[72:75], v6 offset:2560
    v_cvt_pk_bf16_f32 v98, v188, v189
    v_mfma_f32_16x16x32_bf16 a[148:151], a[4:7], a[48:51], a[148:151]
    ds_read_b64 a[116:117], v7 offset:2560
    v_cvt_pk_bf16_f32 v99, v190, v191
    v_fmac_f32 v85, v169, v217
    v_fmac_f32 v87, v169, v225
    v_mfma_f32_16x16x32_bf16 a[152:155], a[8:11], a[48:51], a[152:155]
    ds_read_b64 a[118:119], v7 offset:2568
    buffer_store_dwordx4 v[96:99], v76, s[56:59], s48 offen sc1
    v_mfma_f32_16x16x32_bf16 a[156:159], a[12:15], a[48:51], a[156:159]
    ds_read_b128 a[76:79], v6 offset:2048
    v_pk_mul_f32 v[192:193], v[176:177], v[208:209]
    v_fmac_f32 v81, v170, v202
    v_fmac_f32 v83, v170, v210
    v_mfma_f32_16x16x32_bf16 a[140:143], a[0:3], a[44:47], a[140:143]
    ds_read_b64 a[112:113], v7 offset:2048
    v_pk_mul_f32 v[194:195], v[178:179], v[210:211]
    v_mfma_f32_16x16x32_bf16 a[144:147], a[4:7], a[44:47], a[144:147]
    ds_read_b64 a[114:115], v7 offset:2056
    v_pk_mul_f32 v[196:197], v[180:181], v[212:213]
    v_fmac_f32 v85, v170, v218
    v_fmac_f32 v87, v170, v226
    v_mfma_f32_16x16x32_bf16 a[148:151], a[8:11], a[44:47], a[148:151]
    ds_read_b128 a[80:83], v6 offset:1536
    v_pk_mul_f32 v[198:199], v[182:183], v[214:215]
    v_mfma_f32_16x16x32_bf16 a[152:155], a[12:15], a[44:47], a[152:155]
    ds_read_b64 a[108:109], v7 offset:1536
    v_cvt_pk_bf16_f32 v100, v192, v193
    v_fmac_f32 v81, v171, v203
    v_fmac_f32 v83, v171, v211
    v_mfma_f32_16x16x32_bf16 a[156:159], a[16:19], a[44:47], a[156:159]
    ds_read_b64 a[110:111], v7 offset:1544
    v_cvt_pk_bf16_f32 v101, v194, v195
    v_mfma_f32_16x16x32_bf16 a[136:139], a[0:3], a[40:43], a[136:139]
    ds_read_b128 a[84:87], v6 offset:1024
    v_cvt_pk_bf16_f32 v102, v196, v197
    v_fmac_f32 v85, v171, v219
    v_fmac_f32 v87, v171, v227
    v_mfma_f32_16x16x32_bf16 a[140:143], a[4:7], a[40:43], a[140:143]
    ds_read_b64 a[104:105], v7 offset:1024
    v_cvt_pk_bf16_f32 v103, v198, v199
    v_mfma_f32_16x16x32_bf16 a[144:147], a[8:11], a[40:43], a[144:147]
    ds_read_b64 a[106:107], v7 offset:1032
    buffer_store_dwordx4 v[100:103], v76, s[56:59], s49 offen sc1
    v_fmac_f32 v81, v172, v204
    v_fmac_f32 v83, v172, v212
    v_mfma_f32_16x16x32_bf16 a[148:151], a[12:15], a[40:43], a[148:151]
    ds_read_b128 a[88:91], v6 offset:512
    v_pk_mul_f32 v[184:185], v[176:177], v[216:217]
    v_mfma_f32_16x16x32_bf16 a[152:155], a[16:19], a[40:43], a[152:155]
    ds_read_b64 a[100:101], v7 offset:512
    v_pk_mul_f32 v[186:187], v[178:179], v[218:219]
    v_fmac_f32 v85, v172, v220
    v_fmac_f32 v87, v172, v228
    v_mfma_f32_16x16x32_bf16 a[156:159], a[20:23], a[40:43], a[156:159]
    ds_read_b64 a[102:103], v7 offset:520
    v_pk_mul_f32 v[188:189], v[180:181], v[220:221]
    v_mfma_f32_16x16x32_bf16 a[132:135], a[0:3], a[36:39], a[132:135]
    ds_read_b128 a[92:95], v6 offset:0
    v_pk_mul_f32 v[190:191], v[182:183], v[222:223]
    v_fmac_f32 v81, v173, v205
    v_fmac_f32 v83, v173, v213
    v_mfma_f32_16x16x32_bf16 a[136:139], a[4:7], a[36:39], a[136:139]
    ds_read_b64 a[96:97], v7 offset:0
    v_cvt_pk_bf16_f32 v104, v184, v185
    v_mfma_f32_16x16x32_bf16 a[140:143], a[8:11], a[36:39], a[140:143]
    ds_read_b64 a[98:99], v7 offset:8
    v_cvt_pk_bf16_f32 v105, v186, v187
    v_fmac_f32 v85, v173, v221
    v_fmac_f32 v87, v173, v229
    v_mfma_f32_16x16x32_bf16 a[144:147], a[12:15], a[36:39], a[144:147]
    v_cvt_pk_bf16_f32 v106, v188, v189
    v_mfma_f32_16x16x32_bf16 a[148:151], a[16:19], a[36:39], a[148:151]
    v_cvt_pk_bf16_f32 v107, v190, v191
    v_fmac_f32 v81, v174, v206
    v_fmac_f32 v83, v174, v214
    v_mfma_f32_16x16x32_bf16 a[152:155], a[20:23], a[36:39], a[152:155]
    buffer_store_dwordx4 v[104:107], v76, s[56:59], s50 offen sc1
    v_mfma_f32_16x16x32_bf16 a[156:159], a[24:27], a[36:39], a[156:159]
    v_pk_mul_f32 v[192:193], v[176:177], v[224:225]
    v_fmac_f32 v85, v174, v222
    v_fmac_f32 v87, v174, v230
    v_mfma_f32_16x16x32_bf16 a[128:131], a[0:3], a[32:35], a[128:131]
    v_pk_mul_f32 v[194:195], v[178:179], v[226:227]
    v_mfma_f32_16x16x32_bf16 a[132:135], a[4:7], a[32:35], a[132:135]
    v_pk_mul_f32 v[196:197], v[180:181], v[228:229]
    v_fmac_f32 v81, v175, v207
    v_fmac_f32 v83, v175, v215
    v_mfma_f32_16x16x32_bf16 a[136:139], a[8:11], a[32:35], a[136:139]
    v_pk_mul_f32 v[198:199], v[182:183], v[230:231]
    v_mfma_f32_16x16x32_bf16 a[140:143], a[12:15], a[32:35], a[140:143]
    v_cvt_pk_bf16_f32 v108, v192, v193
    v_fmac_f32 v85, v175, v223
    v_fmac_f32 v87, v175, v231
    v_mfma_f32_16x16x32_bf16 a[144:147], a[16:19], a[32:35], a[144:147]
    v_cvt_pk_bf16_f32 v109, v194, v195
    v_mfma_f32_16x16x32_bf16 a[148:151], a[20:23], a[32:35], a[148:151]
    v_cvt_pk_bf16_f32 v110, v196, v197
    v_mfma_f32_16x16x32_bf16 a[152:155], a[24:27], a[32:35], a[152:155]
    v_cvt_pk_bf16_f32 v111, v198, v199
    v_mfma_f32_16x16x32_bf16 a[156:159], a[28:31], a[32:35], a[156:159]
    buffer_store_dwordx4 v[108:111], v76, s[56:59], s51 offen sc1
    s_waitcnt lgkmcnt(0)
    s_nop 0
    v_mfma_f32_16x16x32_bf16 a[156:159], a[64:67], a[124:127], a[156:159]
    v_lshlrev_b32 v88, 16, v96
    v_and_b32 v89, 0xffff0000, v96
    v_mfma_f32_16x16x32_bf16 a[152:155], a[64:67], a[120:123], a[152:155]
    v_lshlrev_b32 v92, 16, v104
    v_and_b32 v93, 0xffff0000, v104
    v_mfma_f32_16x16x32_bf16 a[156:159], a[68:71], a[120:123], a[156:159]
    v_lshlrev_b32 v90, 16, v100
    v_and_b32 v91, 0xffff0000, v100
    v_mfma_f32_16x16x32_bf16 a[148:151], a[64:67], a[116:119], a[148:151]
    v_lshlrev_b32 v94, 16, v108
    v_and_b32 v95, 0xffff0000, v108
    v_mfma_f32_16x16x32_bf16 a[152:155], a[68:71], a[116:119], a[152:155]
    v_lshlrev_b32 v112, 16, v97
    v_and_b32 v113, 0xffff0000, v97
    v_pk_add_f32 v[88:89], v[88:89], v[112:113]
    v_mfma_f32_16x16x32_bf16 a[156:159], a[72:75], a[116:119], a[156:159]
    v_lshlrev_b32 v116, 16, v105
    v_and_b32 v117, 0xffff0000, v105
    v_pk_add_f32 v[92:93], v[92:93], v[116:117]
    v_mfma_f32_16x16x32_bf16 a[144:147], a[64:67], a[112:115], a[144:147]
    v_lshlrev_b32 v114, 16, v101
    v_and_b32 v115, 0xffff0000, v101
    v_pk_add_f32 v[90:91], v[90:91], v[114:115]
    v_mfma_f32_16x16x32_bf16 a[148:151], a[68:71], a[112:115], a[148:151]
    v_lshlrev_b32 v118, 16, v109
    v_and_b32 v119, 0xffff0000, v109
    v_pk_add_f32 v[94:95], v[94:95], v[118:119]
    v_mfma_f32_16x16x32_bf16 a[152:155], a[72:75], a[112:115], a[152:155]
    v_lshlrev_b32 v112, 16, v98
    v_and_b32 v113, 0xffff0000, v98
    v_pk_add_f32 v[88:89], v[88:89], v[112:113]
    v_mfma_f32_16x16x32_bf16 a[156:159], a[76:79], a[112:115], a[156:159]
    v_lshlrev_b32 v116, 16, v106
    v_and_b32 v117, 0xffff0000, v106
    v_pk_add_f32 v[92:93], v[92:93], v[116:117]
    v_mfma_f32_16x16x32_bf16 a[140:143], a[64:67], a[108:111], a[140:143]
    v_lshlrev_b32 v114, 16, v102
    v_and_b32 v115, 0xffff0000, v102
    v_pk_add_f32 v[90:91], v[90:91], v[114:115]
    v_mfma_f32_16x16x32_bf16 a[144:147], a[68:71], a[108:111], a[144:147]
    v_lshlrev_b32 v118, 16, v110
    v_and_b32 v119, 0xffff0000, v110
    v_pk_add_f32 v[94:95], v[94:95], v[118:119]
    v_mfma_f32_16x16x32_bf16 a[148:151], a[72:75], a[108:111], a[148:151]
    v_lshlrev_b32 v112, 16, v99
    v_and_b32 v113, 0xffff0000, v99
    v_pk_add_f32 v[88:89], v[88:89], v[112:113]
    v_mfma_f32_16x16x32_bf16 a[152:155], a[76:79], a[108:111], a[152:155]
    v_lshlrev_b32 v116, 16, v107
    v_and_b32 v117, 0xffff0000, v107
    v_pk_add_f32 v[92:93], v[92:93], v[116:117]
    v_mfma_f32_16x16x32_bf16 a[156:159], a[80:83], a[108:111], a[156:159]
    v_lshlrev_b32 v114, 16, v103
    v_and_b32 v115, 0xffff0000, v103
    v_pk_add_f32 v[90:91], v[90:91], v[114:115]
    v_mfma_f32_16x16x32_bf16 a[136:139], a[64:67], a[104:107], a[136:139]
    v_lshlrev_b32 v118, 16, v111
    v_and_b32 v119, 0xffff0000, v111
    v_pk_add_f32 v[94:95], v[94:95], v[118:119]
    v_mfma_f32_16x16x32_bf16 a[140:143], a[68:71], a[104:107], a[140:143]
    v_add_f32 v80, v88, v89
    v_mfma_f32_16x16x32_bf16 a[144:147], a[72:75], a[104:107], a[144:147]
    v_add_f32 v82, v90, v91
    v_mfma_f32_16x16x32_bf16 a[148:151], a[76:79], a[104:107], a[148:151]
    v_add_f32 v84, v92, v93
    v_mfma_f32_16x16x32_bf16 a[152:155], a[80:83], a[104:107], a[152:155]
    v_add_f32 v86, v94, v95
    v_mfma_f32_16x16x32_bf16 a[156:159], a[84:87], a[104:107], a[156:159]
    v_permlane32_swap_b32 v80, v81
    v_mfma_f32_16x16x32_bf16 a[132:135], a[64:67], a[100:103], a[132:135]
    v_permlane32_swap_b32 v82, v83
    v_mfma_f32_16x16x32_bf16 a[136:139], a[68:71], a[100:103], a[136:139]
    v_permlane32_swap_b32 v84, v85
    v_mfma_f32_16x16x32_bf16 a[140:143], a[72:75], a[100:103], a[140:143]
    v_permlane32_swap_b32 v86, v87
    v_mfma_f32_16x16x32_bf16 a[144:147], a[76:79], a[100:103], a[144:147]
    v_add_f32 v80, v80, v81
    v_mfma_f32_16x16x32_bf16 a[148:151], a[80:83], a[100:103], a[148:151]
    v_add_f32 v82, v82, v83
    v_mfma_f32_16x16x32_bf16 a[152:155], a[84:87], a[100:103], a[152:155]
    v_add_f32 v84, v84, v85
    v_mfma_f32_16x16x32_bf16 a[156:159], a[88:91], a[100:103], a[156:159]
    v_add_f32 v86, v86, v87
    v_mfma_f32_16x16x32_bf16 a[128:131], a[64:67], a[96:99], a[128:131]
    v_permlane16_swap_b32 v80, v82
    v_mfma_f32_16x16x32_bf16 a[132:135], a[68:71], a[96:99], a[132:135]
    v_permlane16_swap_b32 v84, v86
    v_mfma_f32_16x16x32_bf16 a[136:139], a[72:75], a[96:99], a[136:139]
    v_add_f32 v80, v80, v82
    v_mfma_f32_16x16x32_bf16 a[140:143], a[76:79], a[96:99], a[140:143]
    v_add_f32 v84, v84, v86
    v_mfma_f32_16x16x32_bf16 a[144:147], a[80:83], a[96:99], a[144:147]
    ds_write2st64_b32 v77, v80, v84 offset0:0 offset1:1
    v_mfma_f32_16x16x32_bf16 a[148:151], a[84:87], a[96:99], a[148:151]
    v_mfma_f32_16x16x32_bf16 a[152:155], a[88:91], a[96:99], a[152:155]
    v_mfma_f32_16x16x32_bf16 a[156:159], a[92:95], a[96:99], a[156:159]
    ds_write_b128 v3, a[128:131] offset:0
    ds_write_b128 v3, a[132:135] offset:1024
    ds_write_b128 v3, a[136:139] offset:2048
    ds_write_b128 v3, a[140:143] offset:3072
    ds_write_b128 v3, a[144:147] offset:4096
    s_nop 0
    ds_write_b128 v3, a[148:151] offset:5120
    ds_write_b128 v3, a[152:155] offset:6144
    ds_write_b128 v3, a[156:159] offset:7168
    s_waitcnt lgkmcnt(0)
    s_barrier
    ds_read_b128 v[80:83], v2 offset:0
    ds_read_b128 v[84:87], v2 offset:16
    ds_read_b128 v[88:91], v2 offset:8192
    ds_read_b128 v[92:95], v2 offset:8208
    ds_read_b128 v[96:99], v2 offset:16384
    ds_read_b128 v[100:103], v2 offset:16400
    ds_read_b128 v[104:107], v2 offset:24576
    ds_read_b128 v[108:111], v2 offset:24592
    ds_read_b128 v[16:19], v5 offset:0
    ds_read_b128 v[20:23], v5 offset:512
    ds_read_b128 v[24:27], v5 offset:1024
    ds_read_b128 v[28:31], v5 offset:1536
    s_waitcnt lgkmcnt(8)
    v_add_f32 v80, v80, v88
    v_add_f32 v81, v81, v89
    v_add_f32 v82, v82, v90
    v_add_f32 v83, v83, v91
    v_add_f32 v84, v84, v92
    v_add_f32 v85, v85, v93
    v_add_f32 v86, v86, v94
    v_add_f32 v87, v87, v95
    v_fmac_f32 v32, s64, v80
    v_fmac_f32 v33, s64, v81
    v_fmac_f32 v34, s64, v82
    v_fmac_f32 v35, s64, v83
    v_fmac_f32 v36, s64, v84
    v_fmac_f32 v37, s64, v85
    v_fmac_f32 v38, s64, v86
    v_fmac_f32 v39, s64, v87
    v_cvt_pk_bf16_f32 v8, v32, v33
    v_cvt_pk_bf16_f32 v9, v34, v35
    v_cvt_pk_bf16_f32 v10, v36, v37
    v_cvt_pk_bf16_f32 v11, v38, v39
    global_store_dwordx4 v1, v[8:11], s[38:39] offset:0 sc1
    s_waitcnt lgkmcnt(4)
    v_add_f32 v96, v96, v104
    v_add_f32 v97, v97, v105
    v_add_f32 v98, v98, v106
    v_add_f32 v99, v99, v107
    v_add_f32 v100, v100, v108
    v_add_f32 v101, v101, v109
    v_add_f32 v102, v102, v110
    v_add_f32 v103, v103, v111
    v_fmac_f32 v40, s65, v96
    v_fmac_f32 v41, s65, v97
    v_fmac_f32 v42, s65, v98
    v_fmac_f32 v43, s65, v99
    v_fmac_f32 v44, s65, v100
    v_fmac_f32 v45, s65, v101
    v_fmac_f32 v46, s65, v102
    v_fmac_f32 v47, s65, v103
    v_cvt_pk_bf16_f32 v12, v40, v41
    v_cvt_pk_bf16_f32 v13, v42, v43
    v_cvt_pk_bf16_f32 v14, v44, v45
    v_cvt_pk_bf16_f32 v15, v46, v47
    global_store_dwordx4 v1, v[12:15], s[38:39] offset:128 sc1
    s_waitcnt lgkmcnt(0)
    v_pk_add_f32 v[16:17], v[16:17], v[24:25]
    v_pk_add_f32 v[18:19], v[18:19], v[26:27]
    v_pk_add_f32 v[20:21], v[20:21], v[28:29]
    v_pk_add_f32 v[22:23], v[22:23], v[30:31]
    v_pk_add_f32 v[16:17], v[16:17], v[20:21]
    v_pk_add_f32 v[18:19], v[18:19], v[22:23]
    s_mov_b64 exec, 0xff
    buffer_store_dwordx4 v[16:19], v4, s[56:59], 0 offen sc1
    s_mov_b64 exec, -1
    s_and_b32 s40, s2, 7
    s_lshr_b32 s69, s2, 3
    s_sub_u32 s41, s69, 2
    s_lshl_b32 s8, s40, 2
    s_lshr_b32 s9, s69, 3
    s_add_u32 s8, s8, s9
    s_and_b32 s9, s69, 7
    s_cmp_ge_u32 s69, 2
    s_cbranch_scc1 K2_m1
    s_lshl_b32 s40, s40, 1
    s_add_u32 s40, s40, s69
    s_branch K2_m3
K2_m1:
    s_cmp_ge_u32 s40, 6
    s_cbranch_scc1 K2_m2
    s_mul_i32 s42, s41, 52
    s_lshr_b32 s42, s42, 8
    s_mul_i32 s44, s42, 5
    s_sub_u32 s41, s41, s44
    s_cmp_ge_u32 s40, 3
    s_cselect_b32 s44, 3, 0
    s_sub_u32 s40, s40, s44
    s_mul_i32 s40, s40, 5
    s_add_u32 s41, s41, s40
    s_lshl_b32 s44, s44, 1
    s_add_u32 s40, s42, s44
    s_branch K2_m3
K2_m2:
    s_sub_u32 s40, s40, 6
    s_mul_i32 s40, s40, 30
    s_add_u32 s41, s41, s40
    s_and_b32 s40, s41, 3
    s_add_u32 s40, s40, 12
    s_lshr_b32 s41, s41, 2
K2_m3:
    v_and_b32 v5, 63, v0
    s_mov_b32 s43, s7
    v_lshlrev_b32 v3, 4, v5
    v_bfe_u32 v7, v0, 4, 1
    v_lshlrev_b32 v7, 5, v7
    v_xor_b32 v8, v7, v3
    s_lshl_b32 s49, s40, 1
    s_lshr_b32 s48, s43, 1
    s_add_u32 s49, s49, s48
    s_lshl_b32 s49, s49, 16
    s_and_b32 s48, s43, 1
    s_lshl_b32 s48, s48, 11
    s_add_u32 s49, s49, s48
    v_add_u32 v8, s49, v8
    v_xor_b32 v9, 64, v8
    s_mul_i32 s45, s41, 12
    s_mul_i32 s48, s43, 3
    s_add_u32 s45, s45, s48
    s_lshl_b32 s49, s45, 14
    v_add_u32 v10, s49, v3
    s_add_u32 s49, s49, 16384
    v_add_u32 v11, s49, v3
    s_add_u32 s49, s49, 16384
    v_add_u32 v12, s49, v3
    s_lshl_b32 s60, s43, 11
    s_add_u32 s48, s38, 0x580000
    s_addc_u32 s49, s39, 0
    s_mov_b32 s50, 0x200000
    s_mov_b32 s51, 0x20000
    s_add_u32 s52, s38, 0xa80000
    s_addc_u32 s53, s39, 0
    s_mov_b32 s54, 0x2b0000
    s_mov_b32 s55, 0x20000
    s_and_b32 s14, s43, 1
    s_lshr_b32 s15, s43, 1
    s_lshl_b32 s10, s9, 1
    s_add_u32 s10, s10, s14
    s_lshl_b32 s11, s8, 1
    s_add_u32 s11, s11, s15
    s_mul_i32 s14, s10, 88064
    v_add_u32 v25, s14, v3
    s_xor_b32 s14, s10, 1
    s_mul_i32 s14, s14, 88064
    v_add_u32 v26, s14, v3
    s_mul_i32 s14, s11, 88064
    v_add_u32 v27, s14, v3
    s_xor_b32 s14, s11, 1
    s_mul_i32 s14, s14, 88064
    v_add_u32 v28, s14, v3
    s_lshl_b32 s12, s43, 10
    s_mov_b32 s13, s12
    s_add_u32 s24, s12, 86016
    s_cmp_lt_u32 s43, 2
    s_cselect_b32 s24, s24, 0x10000000
    s_add_u32 s16, s38, 0xe00000
    s_addc_u32 s17, s39, 0
    s_mov_b32 s18, 0x158000
    s_mov_b32 s19, 0x20000
    s_add_u32 s20, s38, 0xf80000
    s_addc_u32 s21, s39, 0
    s_mov_b32 s22, 0x560000
    s_mov_b32 s23, 0x20000
    v_bfe_u32 v6, v0, 4, 2
    v_lshlrev_b32 v6, 10, v6
    v_bfe_u32 v7, v0, 2, 2
    v_lshl_add_u32 v6, v7, 7, v6
    v_bfe_u32 v7, v0, 3, 2
    v_lshl_add_u32 v6, v7, 5, v6
    v_and_b32 v7, 3, v0
    v_lshl_add_u32 v6, v7, 3, v6
    v_xor_b32 v16, 0, v6
    v_xor_b32 v17, 32, v6
    v_xor_b32 v18, 64, v6
    v_xor_b32 v19, 96, v6
    v_bfe_u32 v13, v0, 5, 1
    v_mul_u32_u24 v13, 22528, v13
    v_and_b32 v7, 31, v0
    v_lshl_add_u32 v13, v7, 4, v13
    s_lshl_b32 s63, s45, 7
    v_add_u32 v13, s63, v13
    s_add_u32 s56, s38, 0x2c0000
    s_addc_u32 s57, s39, 0
    s_mov_b32 s58, 0x16000
    s_mov_b32 s59, 0x20000
    s_mov_b32 s64, 45056
    s_lshl_b32 s63, s40, 10
    s_add_u32 s63, s63, 0x290000
    v_add_u32 v15, s63, v3
    s_add_u32 s63, s60, 131072
    v_add_u32 v20, s63, v3
    v_bfe_u32 v21, v0, 4, 2
    v_lshl_add_u32 v21, v21, 4, s63
    v_and_b32 v22, 15, v0
    v_lshl_add_u32 v22, v22, 3, s63
    s_cmp_lt_u32 s69, 2
    s_cselect_b32 s54, 0, s54
    s_waitcnt vmcnt(0)
    s_barrier
    s_cmp_lg_u32 s7, 0
    s_cbranch_scc1 P2_W
    s_mov_b64 exec, 0xff
    v_add_u32 v238, 0x296000, v237
    global_atomic_add v238, v159, s[38:39] sc1
    s_mov_b64 exec, -1
    v_add_u32 v238, 0x296000, v236
    s_bfe_u32 s4, s2, 0x30003
    s_lshl_b32 s4, 1, s4
    s_xor_b32 s5, s4, 0xff
    s_mov_b32 exec_hi, 0
    s_mov_b32 exec_lo, s4
    s_mov_b32 s3, 0
P2_poll:
    global_load_dword v239, v238, s[38:39] sc1
    s_add_u32 s3, s3, 1
    s_cmp_ge_u32 s3, 0x40000
    s_cbranch_scc1 P2_go
    s_waitcnt vmcnt(0)
    v_cmp_ne_u32 vcc, 32, v239
    s_nop 0
    s_and_b32 s4, vcc_lo, 0xff
    s_cselect_b32 s4, s4, s5
    s_cselect_b32 s5, s5, 0
    s_cmp_eq_u32 s4, 0
    s_cbranch_scc1 P2_go
    s_mov_b32 exec_lo, s4
    s_branch P2_poll
P2_go:
    s_barrier
    s_branch P2_W2
P2_W:
P2_W2:
    s_mov_b64 exec, -1
    s_cmp_eq_u32 s7, 0
    s_cbranch_scc1 P2_X
    s_barrier
P2_X:
    s_cmp_lt_u32 s69, 2
    s_cbranch_scc1 K2_stat
    s_add_u32 m0, s60, 0
    s_mov_b32 s61, 0
    buffer_load_dwordx4 v8, s[48:51], s61 offen sc1 lds
    buffer_load_dwordx4 v9, s[48:51], s61 offen offset:1024 sc1 lds
    s_mov_b32 s62, 0
    buffer_load_dwordx4 a[0:3], v10, s[52:55], s62 offen offset:0 sc1
    buffer_load_dwordx4 a[4:7], v11, s[52:55], s62 offen offset:0 sc1
    buffer_load_dwordx4 a[8:11], v12, s[52:55], s62 offen offset:0 sc1
    s_add_u32 m0, s60, 8192
    s_mov_b32 s61, 4096
    buffer_load_dwordx4 v8, s[48:51], s61 offen sc1 lds
    buffer_load_dwordx4 v9, s[48:51], s61 offen offset:1024 sc1 lds
    buffer_load_dwordx4 a[12:15], v10, s[52:55], s62 offen offset:1024 sc1
    buffer_load_dwordx4 a[16:19], v11, s[52:55], s62 offen offset:1024 sc1
    buffer_load_dwordx4 a[20:23], v12, s[52:55], s62 offen offset:1024 sc1
    s_add_u32 m0, s60, 16384
    s_mov_b32 s61, 8192
    buffer_load_dwordx4 v8, s[48:51], s61 offen sc1 lds
    buffer_load_dwordx4 v9, s[48:51], s61 offen offset:1024 sc1 lds
    buffer_load_dwordx4 a[24:27], v10, s[52:55], s62 offen offset:2048 sc1
    buffer_load_dwordx4 a[28:31], v11, s[52:55], s62 offen offset:2048 sc1
    buffer_load_dwordx4 a[32:35], v12, s[52:55], s62 offen offset:2048 sc1
    s_add_u32 m0, s60, 24576
    s_mov_b32 s61, 12288
    buffer_load_dwordx4 v8, s[48:51], s61 offen sc1 lds
    buffer_load_dwordx4 v9, s[48:51], s61 offen offset:1024 sc1 lds
    buffer_load_dwordx4 a[36:39], v10, s[52:55], s62 offen offset:3072 sc1
    buffer_load_dwordx4 a[40:43], v11, s[52:55], s62 offen offset:3072 sc1
    buffer_load_dwordx4 a[44:47], v12, s[52:55], s62 offen offset:3072 sc1
    s_waitcnt vmcnt(18)
    s_barrier
    ds_read_b64_tr_b16 v[32:33], v16 offset:0
    ds_read_b64_tr_b16 v[34:35], v16 offset:512
    ds_read_b64_tr_b16 v[36:37], v17 offset:0
    ds_read_b64_tr_b16 v[38:39], v17 offset:512
    ds_read_b64_tr_b16 v[40:41], v18 offset:0
    ds_read_b64_tr_b16 v[42:43], v18 offset:512
    ds_read_b64_tr_b16 v[44:45], v19 offset:0
    ds_read_b64_tr_b16 v[46:47], v19 offset:512
    ds_read_b64_tr_b16 v[48:49], v16 offset:4096
    ds_read_b64_tr_b16 v[50:51], v16 offset:4608
    ds_read_b64_tr_b16 v[52:53], v17 offset:4096
    ds_read_b64_tr_b16 v[54:55], v17 offset:4608
    ds_read_b64_tr_b16 v[56:57], v18 offset:4096
    ds_read_b64_tr_b16 v[58:59], v18 offset:4608
    ds_read_b64_tr_b16 v[60:61], v19 offset:4096
    ds_read_b64_tr_b16 v[62:63], v19 offset:4608
.p2align 3
    s_waitcnt vmcnt(13) lgkmcnt(0)
    s_barrier
    v_mfma_f32_16x16x32_bf16 v[128:131], a[0:3], v[32:35], 0
    ds_read_b64_tr_b16 v[64:65], v16 offset:8192
    v_mfma_f32_16x16x32_bf16 v[132:135], a[4:7], v[32:35], 0
    ds_read_b64_tr_b16 v[66:67], v16 offset:8704
    v_mfma_f32_16x16x32_bf16 v[136:139], a[8:11], v[32:35], 0
    ds_read_b64_tr_b16 v[68:69], v17 offset:8192
    s_add_u32 m0, s60, 32768
    s_mov_b32 s61, 16384
    buffer_load_dwordx4 v8, s[48:51], s61 offen sc1 lds
    v_mfma_f32_16x16x32_bf16 v[140:143], a[0:3], v[36:39], 0
    ds_read_b64_tr_b16 v[70:71], v17 offset:8704
    v_mfma_f32_16x16x32_bf16 v[144:147], a[4:7], v[36:39], 0
    ds_read_b64_tr_b16 v[72:73], v18 offset:8192
    v_mfma_f32_16x16x32_bf16 v[148:151], a[8:11], v[36:39], 0
    ds_read_b64_tr_b16 v[74:75], v18 offset:8704
    v_mfma_f32_16x16x32_bf16 v[152:155], a[0:3], v[40:43], 0
    ds_read_b64_tr_b16 v[76:77], v19 offset:8192
    buffer_load_dwordx4 v9, s[48:51], s61 offen offset:1024 sc1 lds
    v_mfma_f32_16x16x32_bf16 v[156:159], a[4:7], v[40:43], 0
    ds_read_b64_tr_b16 v[78:79], v19 offset:8704
    v_mfma_f32_16x16x32_bf16 v[160:163], a[8:11], v[40:43], 0
    ds_read_b64_tr_b16 v[80:81], v16 offset:12288
    v_mfma_f32_16x16x32_bf16 v[164:167], a[0:3], v[44:47], 0
    ds_read_b64_tr_b16 v[82:83], v16 offset:12800
    v_mfma_f32_16x16x32_bf16 v[168:171], a[4:7], v[44:47], 0
    ds_read_b64_tr_b16 v[84:85], v17 offset:12288
    s_mov_b32 s62, 4096
    buffer_load_dwordx4 a[48:51], v10, s[52:55], s62 offen offset:0 sc1
    v_mfma_f32_16x16x32_bf16 v[172:175], a[8:11], v[44:47], 0
    ds_read_b64_tr_b16 v[86:87], v17 offset:12800
    v_mfma_f32_16x16x32_bf16 v[176:179], a[0:3], v[48:51], 0
    ds_read_b64_tr_b16 v[88:89], v18 offset:12288
    v_mfma_f32_16x16x32_bf16 v[180:183], a[4:7], v[48:51], 0
    ds_read_b64_tr_b16 v[90:91], v18 offset:12800
    v_mfma_f32_16x16x32_bf16 v[184:187], a[8:11], v[48:51], 0
    ds_read_b64_tr_b16 v[92:93], v19 offset:12288
    buffer_load_dwordx4 a[52:55], v11, s[52:55], s62 offen offset:0 sc1
    v_mfma_f32_16x16x32_bf16 v[188:191], a[0:3], v[52:55], 0
    ds_read_b64_tr_b16 v[94:95], v19 offset:12800
    v_mfma_f32_16x16x32_bf16 v[192:195], a[4:7], v[52:55], 0
    v_mfma_f32_16x16x32_bf16 v[196:199], a[8:11], v[52:55], 0
    buffer_load_dwordx4 a[56:59], v12, s[52:55], s62 offen offset:0 sc1
    v_mfma_f32_16x16x32_bf16 v[200:203], a[0:3], v[56:59], 0
    v_mfma_f32_16x16x32_bf16 v[204:207], a[4:7], v[56:59], 0
    v_mfma_f32_16x16x32_bf16 v[208:211], a[8:11], v[56:59], 0
    v_mfma_f32_16x16x32_bf16 v[212:215], a[0:3], v[60:63], 0
    v_mfma_f32_16x16x32_bf16 v[216:219], a[4:7], v[60:63], 0
    v_mfma_f32_16x16x32_bf16 v[220:223], a[8:11], v[60:63], 0
    s_waitcnt vmcnt(13) lgkmcnt(0)
    s_barrier
    v_mfma_f32_16x16x32_bf16 v[128:131], a[12:15], v[64:67], v[128:131]
    ds_read_b64_tr_b16 v[32:33], v16 offset:16384
    v_mfma_f32_16x16x32_bf16 v[132:135], a[16:19], v[64:67], v[132:135]
    ds_read_b64_tr_b16 v[34:35], v16 offset:16896
    v_mfma_f32_16x16x32_bf16 v[136:139], a[20:23], v[64:67], v[136:139]
    ds_read_b64_tr_b16 v[36:37], v17 offset:16384
    s_add_u32 m0, s60, 40960
    s_mov_b32 s61, 20480
    buffer_load_dwordx4 v8, s[48:51], s61 offen sc1 lds
    v_mfma_f32_16x16x32_bf16 v[140:143], a[12:15], v[68:71], v[140:143]
    ds_read_b64_tr_b16 v[38:39], v17 offset:16896
    v_mfma_f32_16x16x32_bf16 v[144:147], a[16:19], v[68:71], v[144:147]
    ds_read_b64_tr_b16 v[40:41], v18 offset:16384
    v_mfma_f32_16x16x32_bf16 v[148:151], a[20:23], v[68:71], v[148:151]
    ds_read_b64_tr_b16 v[42:43], v18 offset:16896
    v_mfma_f32_16x16x32_bf16 v[152:155], a[12:15], v[72:75], v[152:155]
    ds_read_b64_tr_b16 v[44:45], v19 offset:16384
    buffer_load_dwordx4 v9, s[48:51], s61 offen offset:1024 sc1 lds
    v_mfma_f32_16x16x32_bf16 v[156:159], a[16:19], v[72:75], v[156:159]
    ds_read_b64_tr_b16 v[46:47], v19 offset:16896
    v_mfma_f32_16x16x32_bf16 v[160:163], a[20:23], v[72:75], v[160:163]
    ds_read_b64_tr_b16 v[48:49], v16 offset:20480
    v_mfma_f32_16x16x32_bf16 v[164:167], a[12:15], v[76:79], v[164:167]
    ds_read_b64_tr_b16 v[50:51], v16 offset:20992
    v_mfma_f32_16x16x32_bf16 v[168:171], a[16:19], v[76:79], v[168:171]
    ds_read_b64_tr_b16 v[52:53], v17 offset:20480
    buffer_load_dwordx4 a[60:63], v10, s[52:55], s62 offen offset:1024 sc1
    v_mfma_f32_16x16x32_bf16 v[172:175], a[20:23], v[76:79], v[172:175]
    ds_read_b64_tr_b16 v[54:55], v17 offset:20992
    v_mfma_f32_16x16x32_bf16 v[176:179], a[12:15], v[80:83], v[176:179]
    ds_read_b64_tr_b16 v[56:57], v18 offset:20480
    v_mfma_f32_16x16x32_bf16 v[180:183], a[16:19], v[80:83], v[180:183]
    ds_read_b64_tr_b16 v[58:59], v18 offset:20992
    v_mfma_f32_16x16x32_bf16 v[184:187], a[20:23], v[80:83], v[184:187]
    ds_read_b64_tr_b16 v[60:61], v19 offset:20480
    buffer_load_dwordx4 a[64:67], v11, s[52:55], s62 offen offset:1024 sc1
    v_mfma_f32_16x16x32_bf16 v[188:191], a[12:15], v[84:87], v[188:191]
    ds_read_b64_tr_b16 v[62:63], v19 offset:20992
    v_mfma_f32_16x16x32_bf16 v[192:195], a[16:19], v[84:87], v[192:195]
    v_mfma_f32_16x16x32_bf16 v[196:199], a[20:23], v[84:87], v[196:199]
    buffer_load_dwordx4 a[68:71], v12, s[52:55], s62 offen offset:1024 sc1
    v_mfma_f32_16x16x32_bf16 v[200:203], a[12:15], v[88:91], v[200:203]
    v_mfma_f32_16x16x32_bf16 v[204:207], a[16:19], v[88:91], v[204:207]
    v_mfma_f32_16x16x32_bf16 v[208:211], a[20:23], v[88:91], v[208:211]
    v_mfma_f32_16x16x32_bf16 v[212:215], a[12:15], v[92:95], v[212:215]
    v_mfma_f32_16x16x32_bf16 v[216:219], a[16:19], v[92:95], v[216:219]
    v_mfma_f32_16x16x32_bf16 v[220:223], a[20:23], v[92:95], v[220:223]
    s_waitcnt vmcnt(13) lgkmcnt(0)
    s_barrier
    v_mfma_f32_16x16x32_bf16 v[128:131], a[24:27], v[32:35], v[128:131]
    ds_read_b64_tr_b16 v[64:65], v16 offset:24576
    v_mfma_f32_16x16x32_bf16 v[132:135], a[28:31], v[32:35], v[132:135]
    ds_read_b64_tr_b16 v[66:67], v16 offset:25088
    v_mfma_f32_16x16x32_bf16 v[136:139], a[32:35], v[32:35], v[136:139]
    ds_read_b64_tr_b16 v[68:69], v17 offset:24576
    s_add_u32 m0, s60, 49152
    s_mov_b32 s61, 24576
    buffer_load_dwordx4 v8, s[48:51], s61 offen sc1 lds
    v_mfma_f32_16x16x32_bf16 v[140:143], a[24:27], v[36:39], v[140:143]
    ds_read_b64_tr_b16 v[70:71], v17 offset:25088
    v_mfma_f32_16x16x32_bf16 v[144:147], a[28:31], v[36:39], v[144:147]
    ds_read_b64_tr_b16 v[72:73], v18 offset:24576
    v_mfma_f32_16x16x32_bf16 v[148:151], a[32:35], v[36:39], v[148:151]
    ds_read_b64_tr_b16 v[74:75], v18 offset:25088
    v_mfma_f32_16x16x32_bf16 v[152:155], a[24:27], v[40:43], v[152:155]
    ds_read_b64_tr_b16 v[76:77], v19 offset:24576
    buffer_load_dwordx4 v9, s[48:51], s61 offen offset:1024 sc1 lds
    v_mfma_f32_16x16x32_bf16 v[156:159], a[28:31], v[40:43], v[156:159]
    ds_read_b64_tr_b16 v[78:79], v19 offset:25088
    v_mfma_f32_16x16x32_bf16 v[160:163], a[32:35], v[40:43], v[160:163]
    ds_read_b64_tr_b16 v[80:81], v16 offset:28672
    v_mfma_f32_16x16x32_bf16 v[164:167], a[24:27], v[44:47], v[164:167]
    ds_read_b64_tr_b16 v[82:83], v16 offset:29184
    v_mfma_f32_16x16x32_bf16 v[168:171], a[28:31], v[44:47], v[168:171]
    ds_read_b64_tr_b16 v[84:85], v17 offset:28672
    buffer_load_dwordx4 a[72:75], v10, s[52:55], s62 offen offset:2048 sc1
    v_mfma_f32_16x16x32_bf16 v[172:175], a[32:35], v[44:47], v[172:175]
    ds_read_b64_tr_b16 v[86:87], v17 offset:29184
    v_mfma_f32_16x16x32_bf16 v[176:179], a[24:27], v[48:51], v[176:179]
    ds_read_b64_tr_b16 v[88:89], v18 offset:28672
    v_mfma_f32_16x16x32_bf16 v[180:183], a[28:31], v[48:51], v[180:183]
    ds_read_b64_tr_b16 v[90:91], v18 offset:29184
    v_mfma_f32_16x16x32_bf16 v[184:187], a[32:35], v[48:51], v[184:187]
    ds_read_b64_tr_b16 v[92:93], v19 offset:28672
    buffer_load_dwordx4 a[76:79], v11, s[52:55], s62 offen offset:2048 sc1
    v_mfma_f32_16x16x32_bf16 v[188:191], a[24:27], v[52:55], v[188:191]
    ds_read_b64_tr_b16 v[94:95], v19 offset:29184
    v_mfma_f32_16x16x32_bf16 v[192:195], a[28:31], v[52:55], v[192:195]
    v_mfma_f32_16x16x32_bf16 v[196:199], a[32:35], v[52:55], v[196:199]
    buffer_load_dwordx4 a[80:83], v12, s[52:55], s62 offen offset:2048 sc1
    v_mfma_f32_16x16x32_bf16 v[200:203], a[24:27], v[56:59], v[200:203]
    v_mfma_f32_16x16x32_bf16 v[204:207], a[28:31], v[56:59], v[204:207]
    v_mfma_f32_16x16x32_bf16 v[208:211], a[32:35], v[56:59], v[208:211]
    v_mfma_f32_16x16x32_bf16 v[212:215], a[24:27], v[60:63], v[212:215]
    v_mfma_f32_16x16x32_bf16 v[216:219], a[28:31], v[60:63], v[216:219]
    v_mfma_f32_16x16x32_bf16 v[220:223], a[32:35], v[60:63], v[220:223]
    s_waitcnt vmcnt(13) lgkmcnt(0)
    s_barrier
    v_mfma_f32_16x16x32_bf16 v[128:131], a[36:39], v[64:67], v[128:131]
    ds_read_b64_tr_b16 v[32:33], v16 offset:32768
    v_mfma_f32_16x16x32_bf16 v[132:135], a[40:43], v[64:67], v[132:135]
    ds_read_b64_tr_b16 v[34:35], v16 offset:33280
    v_mfma_f32_16x16x32_bf16 v[136:139], a[44:47], v[64:67], v[136:139]
    ds_read_b64_tr_b16 v[36:37], v17 offset:32768
    s_add_u32 m0, s60, 57344
    s_mov_b32 s61, 28672
    buffer_load_dwordx4 v8, s[48:51], s61 offen sc1 lds
    v_mfma_f32_16x16x32_bf16 v[140:143], a[36:39], v[68:71], v[140:143]
    ds_read_b64_tr_b16 v[38:39], v17 offset:33280
    v_mfma_f32_16x16x32_bf16 v[144:147], a[40:43], v[68:71], v[144:147]
    ds_read_b64_tr_b16 v[40:41], v18 offset:32768
    v_mfma_f32_16x16x32_bf16 v[148:151], a[44:47], v[68:71], v[148:151]
    ds_read_b64_tr_b16 v[42:43], v18 offset:33280
    v_mfma_f32_16x16x32_bf16 v[152:155], a[36:39], v[72:75], v[152:155]
    ds_read_b64_tr_b16 v[44:45], v19 offset:32768
    buffer_load_dwordx4 v9, s[48:51], s61 offen offset:1024 sc1 lds
    v_mfma_f32_16x16x32_bf16 v[156:159], a[40:43], v[72:75], v[156:159]
    ds_read_b64_tr_b16 v[46:47], v19 offset:33280
    v_mfma_f32_16x16x32_bf16 v[160:163], a[44:47], v[72:75], v[160:163]
    ds_read_b64_tr_b16 v[48:49], v16 offset:36864
    v_mfma_f32_16x16x32_bf16 v[164:167], a[36:39], v[76:79], v[164:167]
    ds_read_b64_tr_b16 v[50:51], v16 offset:37376
    v_mfma_f32_16x16x32_bf16 v[168:171], a[40:43], v[76:79], v[168:171]
    ds_read_b64_tr_b16 v[52:53], v17 offset:36864
    buffer_load_dwordx4 a[84:87], v10, s[52:55], s62 offen offset:3072 sc1
    v_mfma_f32_16x16x32_bf16 v[172:175], a[44:47], v[76:79], v[172:175]
    ds_read_b64_tr_b16 v[54:55], v17 offset:37376
    v_mfma_f32_16x16x32_bf16 v[176:179], a[36:39], v[80:83], v[176:179]
    ds_read_b64_tr_b16 v[56:57], v18 offset:36864
    v_mfma_f32_16x16x32_bf16 v[180:183], a[40:43], v[80:83], v[180:183]
    ds_read_b64_tr_b16 v[58:59], v18 offset:37376
    v_mfma_f32_16x16x32_bf16 v[184:187], a[44:47], v[80:83], v[184:187]
    ds_read_b64_tr_b16 v[60:61], v19 offset:36864
    buffer_load_dwordx4 a[88:91], v11, s[52:55], s62 offen offset:3072 sc1
    v_mfma_f32_16x16x32_bf16 v[188:191], a[36:39], v[84:87], v[188:191]
    ds_read_b64_tr_b16 v[62:63], v19 offset:37376
    v_mfma_f32_16x16x32_bf16 v[192:195], a[40:43], v[84:87], v[192:195]
    v_mfma_f32_16x16x32_bf16 v[196:199], a[44:47], v[84:87], v[196:199]
    buffer_load_dwordx4 a[92:95], v12, s[52:55], s62 offen offset:3072 sc1
    v_mfma_f32_16x16x32_bf16 v[200:203], a[36:39], v[88:91], v[200:203]
    v_mfma_f32_16x16x32_bf16 v[204:207], a[40:43], v[88:91], v[204:207]
    v_mfma_f32_16x16x32_bf16 v[208:211], a[44:47], v[88:91], v[208:211]
    v_mfma_f32_16x16x32_bf16 v[212:215], a[36:39], v[92:95], v[212:215]
    v_mfma_f32_16x16x32_bf16 v[216:219], a[40:43], v[92:95], v[216:219]
    v_mfma_f32_16x16x32_bf16 v[220:223], a[44:47], v[92:95], v[220:223]
    s_waitcnt vmcnt(8) lgkmcnt(0)
    s_barrier
    v_mfma_f32_16x16x32_bf16 v[128:131], a[48:51], v[32:35], v[128:131]
    ds_read_b64_tr_b16 v[64:65], v16 offset:40960
    v_mfma_f32_16x16x32_bf16 v[132:135], a[52:55], v[32:35], v[132:135]
    ds_read_b64_tr_b16 v[66:67], v16 offset:41472
    v_mfma_f32_16x16x32_bf16 v[136:139], a[56:59], v[32:35], v[136:139]
    ds_read_b64_tr_b16 v[68:69], v17 offset:40960
    s_add_u32 m0, s60, 65536
    s_mov_b32 s61, 32768
    buffer_load_dwordx4 v8, s[48:51], s61 offen sc1 lds
    v_mfma_f32_16x16x32_bf16 v[140:143], a[48:51], v[36:39], v[140:143]
    ds_read_b64_tr_b16 v[70:71], v17 offset:41472
    v_mfma_f32_16x16x32_bf16 v[144:147], a[52:55], v[36:39], v[144:147]
    ds_read_b64_tr_b16 v[72:73], v18 offset:40960
    v_mfma_f32_16x16x32_bf16 v[148:151], a[56:59], v[36:39], v[148:151]
    ds_read_b64_tr_b16 v[74:75], v18 offset:41472
    v_mfma_f32_16x16x32_bf16 v[152:155], a[48:51], v[40:43], v[152:155]
    ds_read_b64_tr_b16 v[76:77], v19 offset:40960
    buffer_load_dwordx4 v9, s[48:51], s61 offen offset:1024 sc1 lds
    v_mfma_f32_16x16x32_bf16 v[156:159], a[52:55], v[40:43], v[156:159]
    ds_read_b64_tr_b16 v[78:79], v19 offset:41472
    v_mfma_f32_16x16x32_bf16 v[160:163], a[56:59], v[40:43], v[160:163]
    ds_read_b64_tr_b16 v[80:81], v16 offset:45056
    v_mfma_f32_16x16x32_bf16 v[164:167], a[48:51], v[44:47], v[164:167]
    ds_read_b64_tr_b16 v[82:83], v16 offset:45568
    v_mfma_f32_16x16x32_bf16 v[168:171], a[52:55], v[44:47], v[168:171]
    ds_read_b64_tr_b16 v[84:85], v17 offset:45056
    s_mov_b32 s62, 8192
    buffer_load_dwordx4 a[96:99], v10, s[52:55], s62 offen offset:0 sc1
    v_mfma_f32_16x16x32_bf16 v[172:175], a[56:59], v[44:47], v[172:175]
    ds_read_b64_tr_b16 v[86:87], v17 offset:45568
    v_mfma_f32_16x16x32_bf16 v[176:179], a[48:51], v[48:51], v[176:179]
    ds_read_b64_tr_b16 v[88:89], v18 offset:45056
    v_mfma_f32_16x16x32_bf16 v[180:183], a[52:55], v[48:51], v[180:183]
    ds_read_b64_tr_b16 v[90:91], v18 offset:45568
    v_mfma_f32_16x16x32_bf16 v[184:187], a[56:59], v[48:51], v[184:187]
    ds_read_b64_tr_b16 v[92:93], v19 offset:45056
    buffer_load_dwordx4 a[100:103], v11, s[52:55], s62 offen offset:0 sc1
    v_mfma_f32_16x16x32_bf16 v[188:191], a[48:51], v[52:55], v[188:191]
    ds_read_b64_tr_b16 v[94:95], v19 offset:45568
    v_mfma_f32_16x16x32_bf16 v[192:195], a[52:55], v[52:55], v[192:195]
    v_mfma_f32_16x16x32_bf16 v[196:199], a[56:59], v[52:55], v[196:199]
    buffer_load_dwordx4 a[104:107], v12, s[52:55], s62 offen offset:0 sc1
    v_mfma_f32_16x16x32_bf16 v[200:203], a[48:51], v[56:59], v[200:203]
    v_mfma_f32_16x16x32_bf16 v[204:207], a[52:55], v[56:59], v[204:207]
    v_mfma_f32_16x16x32_bf16 v[208:211], a[56:59], v[56:59], v[208:211]
    v_mfma_f32_16x16x32_bf16 v[212:215], a[48:51], v[60:63], v[212:215]
    v_mfma_f32_16x16x32_bf16 v[216:219], a[52:55], v[60:63], v[216:219]
    v_mfma_f32_16x16x32_bf16 v[220:223], a[56:59], v[60:63], v[220:223]
    s_waitcnt vmcnt(15) lgkmcnt(0)
    s_nop 0
    v_mfma_f32_16x16x32_bf16 v[128:131], a[60:63], v[64:67], v[128:131]
    ds_read_b64_tr_b16 v[32:33], v16 offset:49152
    v_mfma_f32_16x16x32_bf16 v[132:135], a[64:67], v[64:67], v[132:135]
    ds_read_b64_tr_b16 v[34:35], v16 offset:49664
    v_mfma_f32_16x16x32_bf16 v[136:139], a[68:71], v[64:67], v[136:139]
    ds_read_b64_tr_b16 v[36:37], v17 offset:49152
    s_add_u32 m0, s60, 73728
    s_mov_b32 s61, 36864
    buffer_load_dwordx4 v8, s[48:51], s61 offen sc1 lds
    v_mfma_f32_16x16x32_bf16 v[140:143], a[60:63], v[68:71], v[140:143]
    ds_read_b64_tr_b16 v[38:39], v17 offset:49664
    v_mfma_f32_16x16x32_bf16 v[144:147], a[64:67], v[68:71], v[144:147]
    ds_read_b64_tr_b16 v[40:41], v18 offset:49152
    v_mfma_f32_16x16x32_bf16 v[148:151], a[68:71], v[68:71], v[148:151]
    ds_read_b64_tr_b16 v[42:43], v18 offset:49664
    v_mfma_f32_16x16x32_bf16 v[152:155], a[60:63], v[72:75], v[152:155]
    ds_read_b64_tr_b16 v[44:45], v19 offset:49152
    buffer_load_dwordx4 v9, s[48:51], s61 offen offset:1024 sc1 lds
    v_mfma_f32_16x16x32_bf16 v[156:159], a[64:67], v[72:75], v[156:159]
    ds_read_b64_tr_b16 v[46:47], v19 offset:49664
    v_mfma_f32_16x16x32_bf16 v[160:163], a[68:71], v[72:75], v[160:163]
    ds_read_b64_tr_b16 v[48:49], v16 offset:53248
    v_mfma_f32_16x16x32_bf16 v[164:167], a[60:63], v[76:79], v[164:167]
    ds_read_b64_tr_b16 v[50:51], v16 offset:53760
    v_mfma_f32_16x16x32_bf16 v[168:171], a[64:67], v[76:79], v[168:171]
    ds_read_b64_tr_b16 v[52:53], v17 offset:53248
    buffer_load_dwordx4 a[108:111], v10, s[52:55], s62 offen offset:1024 sc1
    v_mfma_f32_16x16x32_bf16 v[172:175], a[68:71], v[76:79], v[172:175]
    ds_read_b64_tr_b16 v[54:55], v17 offset:53760
    v_mfma_f32_16x16x32_bf16 v[176:179], a[60:63], v[80:83], v[176:179]
    ds_read_b64_tr_b16 v[56:57], v18 offset:53248
    v_mfma_f32_16x16x32_bf16 v[180:183], a[64:67], v[80:83], v[180:183]
    ds_read_b64_tr_b16 v[58:59], v18 offset:53760
    v_mfma_f32_16x16x32_bf16 v[184:187], a[68:71], v[80:83], v[184:187]
    ds_read_b64_tr_b16 v[60:61], v19 offset:53248
    buffer_load_dwordx4 a[112:115], v11, s[52:55], s62 offen offset:1024 sc1
    v_mfma_f32_16x16x32_bf16 v[188:191], a[60:63], v[84:87], v[188:191]
    ds_read_b64_tr_b16 v[62:63], v19 offset:53760
    v_mfma_f32_16x16x32_bf16 v[192:195], a[64:67], v[84:87], v[192:195]
    v_mfma_f32_16x16x32_bf16 v[196:199], a[68:71], v[84:87], v[196:199]
    buffer_load_dwordx4 a[116:119], v12, s[52:55], s62 offen offset:1024 sc1
    v_mfma_f32_16x16x32_bf16 v[200:203], a[60:63], v[88:91], v[200:203]
    v_mfma_f32_16x16x32_bf16 v[204:207], a[64:67], v[88:91], v[204:207]
    v_mfma_f32_16x16x32_bf16 v[208:211], a[68:71], v[88:91], v[208:211]
    v_mfma_f32_16x16x32_bf16 v[212:215], a[60:63], v[92:95], v[212:215]
    v_mfma_f32_16x16x32_bf16 v[216:219], a[64:67], v[92:95], v[216:219]
    v_mfma_f32_16x16x32_bf16 v[220:223], a[68:71], v[92:95], v[220:223]
    s_waitcnt vmcnt(8) lgkmcnt(0)
    s_barrier
    v_mfma_f32_16x16x32_bf16 v[128:131], a[72:75], v[32:35], v[128:131]
    ds_read_b64_tr_b16 v[64:65], v16 offset:57344
    v_mfma_f32_16x16x32_bf16 v[132:135], a[76:79], v[32:35], v[132:135]
    ds_read_b64_tr_b16 v[66:67], v16 offset:57856
    v_mfma_f32_16x16x32_bf16 v[136:139], a[80:83], v[32:35], v[136:139]
    ds_read_b64_tr_b16 v[68:69], v17 offset:57344
    s_add_u32 m0, s60, 81920
    s_mov_b32 s61, 40960
    buffer_load_dwordx4 v8, s[48:51], s61 offen sc1 lds
    v_mfma_f32_16x16x32_bf16 v[140:143], a[72:75], v[36:39], v[140:143]
    ds_read_b64_tr_b16 v[70:71], v17 offset:57856
    v_mfma_f32_16x16x32_bf16 v[144:147], a[76:79], v[36:39], v[144:147]
    ds_read_b64_tr_b16 v[72:73], v18 offset:57344
    v_mfma_f32_16x16x32_bf16 v[148:151], a[80:83], v[36:39], v[148:151]
    ds_read_b64_tr_b16 v[74:75], v18 offset:57856
    v_mfma_f32_16x16x32_bf16 v[152:155], a[72:75], v[40:43], v[152:155]
    ds_read_b64_tr_b16 v[76:77], v19 offset:57344
    buffer_load_dwordx4 v9, s[48:51], s61 offen offset:1024 sc1 lds
    v_mfma_f32_16x16x32_bf16 v[156:159], a[76:79], v[40:43], v[156:159]
    ds_read_b64_tr_b16 v[78:79], v19 offset:57856
    v_mfma_f32_16x16x32_bf16 v[160:163], a[80:83], v[40:43], v[160:163]
    ds_read_b64_tr_b16 v[80:81], v16 offset:61440
    v_mfma_f32_16x16x32_bf16 v[164:167], a[72:75], v[44:47], v[164:167]
    ds_read_b64_tr_b16 v[82:83], v16 offset:61952
    v_mfma_f32_16x16x32_bf16 v[168:171], a[76:79], v[44:47], v[168:171]
    ds_read_b64_tr_b16 v[84:85], v17 offset:61440
    buffer_load_dwordx4 a[120:123], v10, s[52:55], s62 offen offset:2048 sc1
    v_mfma_f32_16x16x32_bf16 v[172:175], a[80:83], v[44:47], v[172:175]
    ds_read_b64_tr_b16 v[86:87], v17 offset:61952
    v_mfma_f32_16x16x32_bf16 v[176:179], a[72:75], v[48:51], v[176:179]
    ds_read_b64_tr_b16 v[88:89], v18 offset:61440
    v_mfma_f32_16x16x32_bf16 v[180:183], a[76:79], v[48:51], v[180:183]
    ds_read_b64_tr_b16 v[90:91], v18 offset:61952
    v_mfma_f32_16x16x32_bf16 v[184:187], a[80:83], v[48:51], v[184:187]
    ds_read_b64_tr_b16 v[92:93], v19 offset:61440
    buffer_load_dwordx4 a[124:127], v11, s[52:55], s62 offen offset:2048 sc1
    v_mfma_f32_16x16x32_bf16 v[188:191], a[72:75], v[52:55], v[188:191]
    ds_read_b64_tr_b16 v[94:95], v19 offset:61952
    v_mfma_f32_16x16x32_bf16 v[192:195], a[76:79], v[52:55], v[192:195]
    v_mfma_f32_16x16x32_bf16 v[196:199], a[80:83], v[52:55], v[196:199]
    buffer_load_dwordx4 a[128:131], v12, s[52:55], s62 offen offset:2048 sc1
    v_mfma_f32_16x16x32_bf16 v[200:203], a[72:75], v[56:59], v[200:203]
    v_mfma_f32_16x16x32_bf16 v[204:207], a[76:79], v[56:59], v[204:207]
    v_mfma_f32_16x16x32_bf16 v[208:211], a[80:83], v[56:59], v[208:211]
    v_mfma_f32_16x16x32_bf16 v[212:215], a[72:75], v[60:63], v[212:215]
    v_mfma_f32_16x16x32_bf16 v[216:219], a[76:79], v[60:63], v[216:219]
    v_mfma_f32_16x16x32_bf16 v[220:223], a[80:83], v[60:63], v[220:223]
    s_waitcnt vmcnt(15) lgkmcnt(0)
    s_nop 0
    v_add_u32 v16, 0x10000, v16
    v_add_u32 v17, 0x10000, v17
    v_add_u32 v18, 0x10000, v18
    v_add_u32 v19, 0x10000, v19
    v_mfma_f32_16x16x32_bf16 v[128:131], a[84:87], v[64:67], v[128:131]
    ds_read_b64_tr_b16 v[32:33], v16 offset:0
    v_mfma_f32_16x16x32_bf16 v[132:135], a[88:91], v[64:67], v[132:135]
    ds_read_b64_tr_b16 v[34:35], v16 offset:512
    v_mfma_f32_16x16x32_bf16 v[136:139], a[92:95], v[64:67], v[136:139]
    ds_read_b64_tr_b16 v[36:37], v17 offset:0
    s_add_u32 m0, s60, 90112
    s_mov_b32 s61, 45056
    buffer_load_dwordx4 v8, s[48:51], s61 offen sc1 lds
    v_mfma_f32_16x16x32_bf16 v[140:143], a[84:87], v[68:71], v[140:143]
    ds_read_b64_tr_b16 v[38:39], v17 offset:512
    v_mfma_f32_16x16x32_bf16 v[144:147], a[88:91], v[68:71], v[144:147]
    ds_read_b64_tr_b16 v[40:41], v18 offset:0
    v_mfma_f32_16x16x32_bf16 v[148:151], a[92:95], v[68:71], v[148:151]
    ds_read_b64_tr_b16 v[42:43], v18 offset:512
    v_mfma_f32_16x16x32_bf16 v[152:155], a[84:87], v[72:75], v[152:155]
    ds_read_b64_tr_b16 v[44:45], v19 offset:0
    buffer_load_dwordx4 v9, s[48:51], s61 offen offset:1024 sc1 lds
    v_mfma_f32_16x16x32_bf16 v[156:159], a[88:91], v[72:75], v[156:159]
    ds_read_b64_tr_b16 v[46:47], v19 offset:512
    v_mfma_f32_16x16x32_bf16 v[160:163], a[92:95], v[72:75], v[160:163]
    ds_read_b64_tr_b16 v[48:49], v16 offset:4096
    v_mfma_f32_16x16x32_bf16 v[164:167], a[84:87], v[76:79], v[164:167]
    ds_read_b64_tr_b16 v[50:51], v16 offset:4608
    v_mfma_f32_16x16x32_bf16 v[168:171], a[88:91], v[76:79], v[168:171]
    ds_read_b64_tr_b16 v[52:53], v17 offset:4096
    buffer_load_dwordx4 a[132:135], v10, s[52:55], s62 offen offset:3072 sc1
    v_mfma_f32_16x16x32_bf16 v[172:175], a[92:95], v[76:79], v[172:175]
    ds_read_b64_tr_b16 v[54:55], v17 offset:4608
    v_mfma_f32_16x16x32_bf16 v[176:179], a[84:87], v[80:83], v[176:179]
    ds_read_b64_tr_b16 v[56:57], v18 offset:4096
    v_mfma_f32_16x16x32_bf16 v[180:183], a[88:91], v[80:83], v[180:183]
    ds_read_b64_tr_b16 v[58:59], v18 offset:4608
    v_mfma_f32_16x16x32_bf16 v[184:187], a[92:95], v[80:83], v[184:187]
    ds_read_b64_tr_b16 v[60:61], v19 offset:4096
    buffer_load_dwordx4 a[136:139], v11, s[52:55], s62 offen offset:3072 sc1
    v_mfma_f32_16x16x32_bf16 v[188:191], a[84:87], v[84:87], v[188:191]
    ds_read_b64_tr_b16 v[62:63], v19 offset:4608
    v_mfma_f32_16x16x32_bf16 v[192:195], a[88:91], v[84:87], v[192:195]
    v_mfma_f32_16x16x32_bf16 v[196:199], a[92:95], v[84:87], v[196:199]
    buffer_load_dwordx4 a[140:143], v12, s[52:55], s62 offen offset:3072 sc1
    v_mfma_f32_16x16x32_bf16 v[200:203], a[84:87], v[88:91], v[200:203]
    v_mfma_f32_16x16x32_bf16 v[204:207], a[88:91], v[88:91], v[204:207]
    v_mfma_f32_16x16x32_bf16 v[208:211], a[92:95], v[88:91], v[208:211]
    v_mfma_f32_16x16x32_bf16 v[212:215], a[84:87], v[92:95], v[212:215]
    v_mfma_f32_16x16x32_bf16 v[216:219], a[88:91], v[92:95], v[216:219]
    v_mfma_f32_16x16x32_bf16 v[220:223], a[92:95], v[92:95], v[220:223]
    s_waitcnt vmcnt(8) lgkmcnt(0)
    s_barrier
    v_mfma_f32_16x16x32_bf16 v[128:131], a[96:99], v[32:35], v[128:131]
    ds_read_b64_tr_b16 v[64:65], v16 offset:8192
    v_mfma_f32_16x16x32_bf16 v[132:135], a[100:103], v[32:35], v[132:135]
    ds_read_b64_tr_b16 v[66:67], v16 offset:8704
    v_mfma_f32_16x16x32_bf16 v[136:139], a[104:107], v[32:35], v[136:139]
    ds_read_b64_tr_b16 v[68:69], v17 offset:8192
    s_add_u32 m0, s60, 98304
    s_mov_b32 s61, 49152
    buffer_load_dwordx4 v8, s[48:51], s61 offen sc1 lds
    v_mfma_f32_16x16x32_bf16 v[140:143], a[96:99], v[36:39], v[140:143]
    ds_read_b64_tr_b16 v[70:71], v17 offset:8704
    v_mfma_f32_16x16x32_bf16 v[144:147], a[100:103], v[36:39], v[144:147]
    ds_read_b64_tr_b16 v[72:73], v18 offset:8192
    v_mfma_f32_16x16x32_bf16 v[148:151], a[104:107], v[36:39], v[148:151]
    ds_read_b64_tr_b16 v[74:75], v18 offset:8704
    v_mfma_f32_16x16x32_bf16 v[152:155], a[96:99], v[40:43], v[152:155]
    ds_read_b64_tr_b16 v[76:77], v19 offset:8192
    buffer_load_dwordx4 v9, s[48:51], s61 offen offset:1024 sc1 lds
    v_mfma_f32_16x16x32_bf16 v[156:159], a[100:103], v[40:43], v[156:159]
    ds_read_b64_tr_b16 v[78:79], v19 offset:8704
    v_mfma_f32_16x16x32_bf16 v[160:163], a[104:107], v[40:43], v[160:163]
    ds_read_b64_tr_b16 v[80:81], v16 offset:12288
    v_mfma_f32_16x16x32_bf16 v[164:167], a[96:99], v[44:47], v[164:167]
    ds_read_b64_tr_b16 v[82:83], v16 offset:12800
    v_mfma_f32_16x16x32_bf16 v[168:171], a[100:103], v[44:47], v[168:171]
    ds_read_b64_tr_b16 v[84:85], v17 offset:12288
    s_mov_b32 s62, 12288
    buffer_load_dwordx4 a[144:147], v10, s[52:55], s62 offen offset:0 sc1
    v_mfma_f32_16x16x32_bf16 v[172:175], a[104:107], v[44:47], v[172:175]
    ds_read_b64_tr_b16 v[86:87], v17 offset:12800
    v_mfma_f32_16x16x32_bf16 v[176:179], a[96:99], v[48:51], v[176:179]
    ds_read_b64_tr_b16 v[88:89], v18 offset:12288
    v_mfma_f32_16x16x32_bf16 v[180:183], a[100:103], v[48:51], v[180:183]
    ds_read_b64_tr_b16 v[90:91], v18 offset:12800
    v_mfma_f32_16x16x32_bf16 v[184:187], a[104:107], v[48:51], v[184:187]
    ds_read_b64_tr_b16 v[92:93], v19 offset:12288
    buffer_load_dwordx4 a[148:151], v11, s[52:55], s62 offen offset:0 sc1
    v_mfma_f32_16x16x32_bf16 v[188:191], a[96:99], v[52:55], v[188:191]
    ds_read_b64_tr_b16 v[94:95], v19 offset:12800
    v_mfma_f32_16x16x32_bf16 v[192:195], a[100:103], v[52:55], v[192:195]
    v_mfma_f32_16x16x32_bf16 v[196:199], a[104:107], v[52:55], v[196:199]
    buffer_load_dwordx4 a[152:155], v12, s[52:55], s62 offen offset:0 sc1
    v_mfma_f32_16x16x32_bf16 v[200:203], a[96:99], v[56:59], v[200:203]
    v_mfma_f32_16x16x32_bf16 v[204:207], a[100:103], v[56:59], v[204:207]
    v_mfma_f32_16x16x32_bf16 v[208:211], a[104:107], v[56:59], v[208:211]
    v_mfma_f32_16x16x32_bf16 v[212:215], a[96:99], v[60:63], v[212:215]
    v_mfma_f32_16x16x32_bf16 v[216:219], a[100:103], v[60:63], v[216:219]
    v_mfma_f32_16x16x32_bf16 v[220:223], a[104:107], v[60:63], v[220:223]
    s_waitcnt vmcnt(15) lgkmcnt(0)
    s_nop 0
    v_mfma_f32_16x16x32_bf16 v[128:131], a[108:111], v[64:67], v[128:131]
    ds_read_b64_tr_b16 v[32:33], v16 offset:16384
    v_mfma_f32_16x16x32_bf16 v[132:135], a[112:115], v[64:67], v[132:135]
    ds_read_b64_tr_b16 v[34:35], v16 offset:16896
    v_mfma_f32_16x16x32_bf16 v[136:139], a[116:119], v[64:67], v[136:139]
    ds_read_b64_tr_b16 v[36:37], v17 offset:16384
    s_add_u32 m0, s60, 106496
    s_mov_b32 s61, 53248
    buffer_load_dwordx4 v8, s[48:51], s61 offen sc1 lds
    v_mfma_f32_16x16x32_bf16 v[140:143], a[108:111], v[68:71], v[140:143]
    ds_read_b64_tr_b16 v[38:39], v17 offset:16896
    v_mfma_f32_16x16x32_bf16 v[144:147], a[112:115], v[68:71], v[144:147]
    ds_read_b64_tr_b16 v[40:41], v18 offset:16384
    v_mfma_f32_16x16x32_bf16 v[148:151], a[116:119], v[68:71], v[148:151]
    ds_read_b64_tr_b16 v[42:43], v18 offset:16896
    v_mfma_f32_16x16x32_bf16 v[152:155], a[108:111], v[72:75], v[152:155]
    ds_read_b64_tr_b16 v[44:45], v19 offset:16384
    buffer_load_dwordx4 v9, s[48:51], s61 offen offset:1024 sc1 lds
    v_mfma_f32_16x16x32_bf16 v[156:159], a[112:115], v[72:75], v[156:159]
    ds_read_b64_tr_b16 v[46:47], v19 offset:16896
    v_mfma_f32_16x16x32_bf16 v[160:163], a[116:119], v[72:75], v[160:163]
    ds_read_b64_tr_b16 v[48:49], v16 offset:20480
    v_mfma_f32_16x16x32_bf16 v[164:167], a[108:111], v[76:79], v[164:167]
    ds_read_b64_tr_b16 v[50:51], v16 offset:20992
    v_mfma_f32_16x16x32_bf16 v[168:171], a[112:115], v[76:79], v[168:171]
    ds_read_b64_tr_b16 v[52:53], v17 offset:20480
    buffer_load_dwordx4 a[156:159], v10, s[52:55], s62 offen offset:1024 sc1
    v_mfma_f32_16x16x32_bf16 v[172:175], a[116:119], v[76:79], v[172:175]
    ds_read_b64_tr_b16 v[54:55], v17 offset:20992
    v_mfma_f32_16x16x32_bf16 v[176:179], a[108:111], v[80:83], v[176:179]
    ds_read_b64_tr_b16 v[56:57], v18 offset:20480
    v_mfma_f32_16x16x32_bf16 v[180:183], a[112:115], v[80:83], v[180:183]
    ds_read_b64_tr_b16 v[58:59], v18 offset:20992
    v_mfma_f32_16x16x32_bf16 v[184:187], a[116:119], v[80:83], v[184:187]
    ds_read_b64_tr_b16 v[60:61], v19 offset:20480
    buffer_load_dwordx4 a[160:163], v11, s[52:55], s62 offen offset:1024 sc1
    v_mfma_f32_16x16x32_bf16 v[188:191], a[108:111], v[84:87], v[188:191]
    ds_read_b64_tr_b16 v[62:63], v19 offset:20992
    v_mfma_f32_16x16x32_bf16 v[192:195], a[112:115], v[84:87], v[192:195]
    v_mfma_f32_16x16x32_bf16 v[196:199], a[116:119], v[84:87], v[196:199]
    buffer_load_dwordx4 a[164:167], v12, s[52:55], s62 offen offset:1024 sc1
    v_mfma_f32_16x16x32_bf16 v[200:203], a[108:111], v[88:91], v[200:203]
    v_mfma_f32_16x16x32_bf16 v[204:207], a[112:115], v[88:91], v[204:207]
    v_mfma_f32_16x16x32_bf16 v[208:211], a[116:119], v[88:91], v[208:211]
    v_mfma_f32_16x16x32_bf16 v[212:215], a[108:111], v[92:95], v[212:215]
    v_mfma_f32_16x16x32_bf16 v[216:219], a[112:115], v[92:95], v[216:219]
    v_mfma_f32_16x16x32_bf16 v[220:223], a[116:119], v[92:95], v[220:223]
    s_waitcnt vmcnt(8) lgkmcnt(0)
    s_barrier
    v_mfma_f32_16x16x32_bf16 v[128:131], a[120:123], v[32:35], v[128:131]
    ds_read_b64_tr_b16 v[64:65], v16 offset:24576
    v_mfma_f32_16x16x32_bf16 v[132:135], a[124:127], v[32:35], v[132:135]
    ds_read_b64_tr_b16 v[66:67], v16 offset:25088
    s_add_u32 m0, s60, 114688
    s_mov_b32 s61, 57344
    buffer_load_dwordx4 v8, s[48:51], s61 offen sc1 lds
    v_mfma_f32_16x16x32_bf16 v[136:139], a[128:131], v[32:35], v[136:139]
    ds_read_b64_tr_b16 v[68:69], v17 offset:24576
    v_mfma_f32_16x16x32_bf16 v[140:143], a[120:123], v[36:39], v[140:143]
    ds_read_b64_tr_b16 v[70:71], v17 offset:25088
    buffer_load_dwordx4 v9, s[48:51], s61 offen offset:1024 sc1 lds
    v_mfma_f32_16x16x32_bf16 v[144:147], a[124:127], v[36:39], v[144:147]
    ds_read_b64_tr_b16 v[72:73], v18 offset:24576
    v_mfma_f32_16x16x32_bf16 v[148:151], a[128:131], v[36:39], v[148:151]
    ds_read_b64_tr_b16 v[74:75], v18 offset:25088
    v_mfma_f32_16x16x32_bf16 v[152:155], a[120:123], v[40:43], v[152:155]
    ds_read_b64_tr_b16 v[76:77], v19 offset:24576
    buffer_load_dwordx4 a[168:171], v10, s[52:55], s62 offen offset:2048 sc1
    v_mfma_f32_16x16x32_bf16 v[156:159], a[124:127], v[40:43], v[156:159]
    ds_read_b64_tr_b16 v[78:79], v19 offset:25088
    v_mfma_f32_16x16x32_bf16 v[160:163], a[128:131], v[40:43], v[160:163]
    ds_read_b64_tr_b16 v[80:81], v16 offset:28672
    v_mfma_f32_16x16x32_bf16 v[164:167], a[120:123], v[44:47], v[164:167]
    ds_read_b64_tr_b16 v[82:83], v16 offset:29184
    v_mfma_f32_16x16x32_bf16 v[168:171], a[124:127], v[44:47], v[168:171]
    ds_read_b64_tr_b16 v[84:85], v17 offset:28672
    buffer_load_dwordx4 a[172:175], v11, s[52:55], s62 offen offset:2048 sc1
    v_mfma_f32_16x16x32_bf16 v[172:175], a[128:131], v[44:47], v[172:175]
    ds_read_b64_tr_b16 v[86:87], v17 offset:29184
    v_mfma_f32_16x16x32_bf16 v[176:179], a[120:123], v[48:51], v[176:179]
    ds_read_b64_tr_b16 v[88:89], v18 offset:28672
    v_mfma_f32_16x16x32_bf16 v[180:183], a[124:127], v[48:51], v[180:183]
    ds_read_b64_tr_b16 v[90:91], v18 offset:29184
    v_mfma_f32_16x16x32_bf16 v[184:187], a[128:131], v[48:51], v[184:187]
    ds_read_b64_tr_b16 v[92:93], v19 offset:28672
    buffer_load_dwordx4 a[176:179], v12, s[52:55], s62 offen offset:2048 sc1
    v_mfma_f32_16x16x32_bf16 v[188:191], a[120:123], v[52:55], v[188:191]
    ds_read_b64_tr_b16 v[94:95], v19 offset:29184
    v_mfma_f32_16x16x32_bf16 v[192:195], a[124:127], v[52:55], v[192:195]
    v_mfma_f32_16x16x32_bf16 v[196:199], a[128:131], v[52:55], v[196:199]
    buffer_load_dwordx4 v[240:243], v13, s[56:59], 0 offen sc1
    v_mfma_f32_16x16x32_bf16 v[200:203], a[120:123], v[56:59], v[200:203]
    v_mfma_f32_16x16x32_bf16 v[204:207], a[124:127], v[56:59], v[204:207]
    buffer_load_dwordx4 v[244:247], v13, s[56:59], s64 offen sc1
    v_mfma_f32_16x16x32_bf16 v[208:211], a[128:131], v[56:59], v[208:211]
    v_mfma_f32_16x16x32_bf16 v[212:215], a[120:123], v[60:63], v[212:215]
    v_mfma_f32_16x16x32_bf16 v[216:219], a[124:127], v[60:63], v[216:219]
    v_mfma_f32_16x16x32_bf16 v[220:223], a[128:131], v[60:63], v[220:223]
    s_waitcnt vmcnt(17) lgkmcnt(0)
    s_nop 0
    v_mfma_f32_16x16x32_bf16 v[128:131], a[132:135], v[64:67], v[128:131]
    ds_read_b64_tr_b16 v[32:33], v16 offset:32768
    v_mfma_f32_16x16x32_bf16 v[132:135], a[136:139], v[64:67], v[132:135]
    ds_read_b64_tr_b16 v[34:35], v16 offset:33280
    v_mfma_f32_16x16x32_bf16 v[136:139], a[140:143], v[64:67], v[136:139]
    ds_read_b64_tr_b16 v[36:37], v17 offset:32768
    s_add_u32 m0, s60, 122880
    s_mov_b32 s61, 61440
    buffer_load_dwordx4 v8, s[48:51], s61 offen sc1 lds
    v_mfma_f32_16x16x32_bf16 v[140:143], a[132:135], v[68:71], v[140:143]
    ds_read_b64_tr_b16 v[38:39], v17 offset:33280
    v_mfma_f32_16x16x32_bf16 v[144:147], a[136:139], v[68:71], v[144:147]
    ds_read_b64_tr_b16 v[40:41], v18 offset:32768
    v_mfma_f32_16x16x32_bf16 v[148:151], a[140:143], v[68:71], v[148:151]
    ds_read_b64_tr_b16 v[42:43], v18 offset:33280
    v_mfma_f32_16x16x32_bf16 v[152:155], a[132:135], v[72:75], v[152:155]
    ds_read_b64_tr_b16 v[44:45], v19 offset:32768
    buffer_load_dwordx4 v9, s[48:51], s61 offen offset:1024 sc1 lds
    v_mfma_f32_16x16x32_bf16 v[156:159], a[136:139], v[72:75], v[156:159]
    ds_read_b64_tr_b16 v[46:47], v19 offset:33280
    v_mfma_f32_16x16x32_bf16 v[160:163], a[140:143], v[72:75], v[160:163]
    ds_read_b64_tr_b16 v[48:49], v16 offset:36864
    v_mfma_f32_16x16x32_bf16 v[164:167], a[132:135], v[76:79], v[164:167]
    ds_read_b64_tr_b16 v[50:51], v16 offset:37376
    v_mfma_f32_16x16x32_bf16 v[168:171], a[136:139], v[76:79], v[168:171]
    ds_read_b64_tr_b16 v[52:53], v17 offset:36864
    buffer_load_dwordx4 a[180:183], v10, s[52:55], s62 offen offset:3072 sc1
    v_mfma_f32_16x16x32_bf16 v[172:175], a[140:143], v[76:79], v[172:175]
    ds_read_b64_tr_b16 v[54:55], v17 offset:37376
    v_mfma_f32_16x16x32_bf16 v[176:179], a[132:135], v[80:83], v[176:179]
    ds_read_b64_tr_b16 v[56:57], v18 offset:36864
    v_mfma_f32_16x16x32_bf16 v[180:183], a[136:139], v[80:83], v[180:183]
    ds_read_b64_tr_b16 v[58:59], v18 offset:37376
    v_mfma_f32_16x16x32_bf16 v[184:187], a[140:143], v[80:83], v[184:187]
    ds_read_b64_tr_b16 v[60:61], v19 offset:36864
    buffer_load_dwordx4 a[184:187], v11, s[52:55], s62 offen offset:3072 sc1
    v_mfma_f32_16x16x32_bf16 v[188:191], a[132:135], v[84:87], v[188:191]
    ds_read_b64_tr_b16 v[62:63], v19 offset:37376
    v_mfma_f32_16x16x32_bf16 v[192:195], a[136:139], v[84:87], v[192:195]
    v_mfma_f32_16x16x32_bf16 v[196:199], a[140:143], v[84:87], v[196:199]
    buffer_load_dwordx4 a[188:191], v12, s[52:55], s62 offen offset:3072 sc1
    v_mfma_f32_16x16x32_bf16 v[200:203], a[132:135], v[88:91], v[200:203]
    v_mfma_f32_16x16x32_bf16 v[204:207], a[136:139], v[88:91], v[204:207]
    v_mfma_f32_16x16x32_bf16 v[208:211], a[140:143], v[88:91], v[208:211]
    v_mfma_f32_16x16x32_bf16 v[212:215], a[132:135], v[92:95], v[212:215]
    v_mfma_f32_16x16x32_bf16 v[216:219], a[136:139], v[92:95], v[216:219]
    v_mfma_f32_16x16x32_bf16 v[220:223], a[140:143], v[92:95], v[220:223]
    s_waitcnt vmcnt(5) lgkmcnt(0)
    s_barrier
    v_mfma_f32_16x16x32_bf16 v[128:131], a[144:147], v[32:35], v[128:131]
    ds_read_b64_tr_b16 v[64:65], v16 offset:40960
    v_add_f32 v240, v240, v244
    v_mfma_f32_16x16x32_bf16 v[132:135], a[148:151], v[32:35], v[132:135]
    ds_read_b64_tr_b16 v[66:67], v16 offset:41472
    v_add_f32 v241, v241, v245
    v_mfma_f32_16x16x32_bf16 v[136:139], a[152:155], v[32:35], v[136:139]
    ds_read_b64_tr_b16 v[68:69], v17 offset:40960
    buffer_load_dwordx4 a[0:3], v25, s[16:19], s12 offen sc1
    v_add_f32 v242, v242, v246
    v_mfma_f32_16x16x32_bf16 v[140:143], a[144:147], v[36:39], v[140:143]
    ds_read_b64_tr_b16 v[70:71], v17 offset:41472
    v_add_f32 v243, v243, v247
    v_mfma_f32_16x16x32_bf16 v[144:147], a[148:151], v[36:39], v[144:147]
    ds_read_b64_tr_b16 v[72:73], v18 offset:40960
    v_mov_b32 v244, v240
    v_mfma_f32_16x16x32_bf16 v[148:151], a[152:155], v[36:39], v[148:151]
    ds_read_b64_tr_b16 v[74:75], v18 offset:41472
    v_mov_b32 v245, v241
    v_mfma_f32_16x16x32_bf16 v[152:155], a[144:147], v[40:43], v[152:155]
    ds_read_b64_tr_b16 v[76:77], v19 offset:40960
    buffer_load_dwordx4 a[4:7], v26, s[16:19], s12 offen sc1
    s_add_u32 s12, s12, 4096
    v_mov_b32 v246, v242
    v_mfma_f32_16x16x32_bf16 v[156:159], a[148:151], v[40:43], v[156:159]
    ds_read_b64_tr_b16 v[78:79], v19 offset:41472
    v_mov_b32 v247, v243
    v_mfma_f32_16x16x32_bf16 v[160:163], a[152:155], v[40:43], v[160:163]
    ds_read_b64_tr_b16 v[80:81], v16 offset:45056
    v_permlane32_swap_b32 v240, v244
    v_mfma_f32_16x16x32_bf16 v[164:167], a[144:147], v[44:47], v[164:167]
    ds_read_b64_tr_b16 v[82:83], v16 offset:45568
    v_permlane32_swap_b32 v241, v245
    v_mfma_f32_16x16x32_bf16 v[168:171], a[148:151], v[44:47], v[168:171]
    ds_read_b64_tr_b16 v[84:85], v17 offset:45056
    buffer_load_dwordx4 a[8:11], v25, s[16:19], s12 offen sc1
    v_permlane32_swap_b32 v242, v246
    v_mfma_f32_16x16x32_bf16 v[172:175], a[152:155], v[44:47], v[172:175]
    ds_read_b64_tr_b16 v[86:87], v17 offset:45568
    v_permlane32_swap_b32 v243, v247
    v_mfma_f32_16x16x32_bf16 v[176:179], a[144:147], v[48:51], v[176:179]
    ds_read_b64_tr_b16 v[88:89], v18 offset:45056
    v_add_f32 v240, v240, v244
    v_mfma_f32_16x16x32_bf16 v[180:183], a[148:151], v[48:51], v[180:183]
    ds_read_b64_tr_b16 v[90:91], v18 offset:45568
    v_add_f32 v241, v241, v245
    v_mfma_f32_16x16x32_bf16 v[184:187], a[152:155], v[48:51], v[184:187]
    ds_read_b64_tr_b16 v[92:93], v19 offset:45056
    buffer_load_dwordx4 a[12:15], v26, s[16:19], s12 offen sc1
    s_add_u32 s12, s12, 4096
    v_add_f32 v242, v242, v246
    v_mfma_f32_16x16x32_bf16 v[188:191], a[144:147], v[52:55], v[188:191]
    ds_read_b64_tr_b16 v[94:95], v19 offset:45568
    v_add_f32 v243, v243, v247
    v_mfma_f32_16x16x32_bf16 v[192:195], a[148:151], v[52:55], v[192:195]
    ds_write_b128 v20, v[240:243]
    v_mfma_f32_16x16x32_bf16 v[196:199], a[152:155], v[52:55], v[196:199]
    buffer_load_dwordx4 a[16:19], v25, s[16:19], s12 offen sc1
    v_mfma_f32_16x16x32_bf16 v[200:203], a[144:147], v[56:59], v[200:203]
    v_mfma_f32_16x16x32_bf16 v[204:207], a[148:151], v[56:59], v[204:207]
    v_mfma_f32_16x16x32_bf16 v[208:211], a[152:155], v[56:59], v[208:211]
    v_mfma_f32_16x16x32_bf16 v[212:215], a[144:147], v[60:63], v[212:215]
    v_mfma_f32_16x16x32_bf16 v[216:219], a[148:151], v[60:63], v[216:219]
    v_mfma_f32_16x16x32_bf16 v[220:223], a[152:155], v[60:63], v[220:223]
    s_waitcnt vmcnt(17) lgkmcnt(0)
    s_nop 0
    v_mfma_f32_16x16x32_bf16 v[128:131], a[156:159], v[64:67], v[128:131]
    ds_read_b64_tr_b16 v[32:33], v16 offset:49152
    v_mfma_f32_16x16x32_bf16 v[132:135], a[160:163], v[64:67], v[132:135]
    ds_read_b64_tr_b16 v[34:35], v16 offset:49664
    v_mfma_f32_16x16x32_bf16 v[136:139], a[164:167], v[64:67], v[136:139]
    ds_read_b64_tr_b16 v[36:37], v17 offset:49152
    global_load_dwordx4 v[240:243], v15, s[38:39] sc1
    v_mfma_f32_16x16x32_bf16 v[140:143], a[156:159], v[68:71], v[140:143]
    ds_read_b64_tr_b16 v[38:39], v17 offset:49664
    v_mfma_f32_16x16x32_bf16 v[144:147], a[160:163], v[68:71], v[144:147]
    ds_read_b64_tr_b16 v[40:41], v18 offset:49152
    v_mfma_f32_16x16x32_bf16 v[148:151], a[164:167], v[68:71], v[148:151]
    ds_read_b64_tr_b16 v[42:43], v18 offset:49664
    v_mfma_f32_16x16x32_bf16 v[152:155], a[156:159], v[72:75], v[152:155]
    ds_read_b64_tr_b16 v[44:45], v19 offset:49152
    buffer_load_dwordx4 a[20:23], v26, s[16:19], s12 offen sc1
    s_add_u32 s12, s12, 4096
    v_mfma_f32_16x16x32_bf16 v[156:159], a[160:163], v[72:75], v[156:159]
    ds_read_b64_tr_b16 v[46:47], v19 offset:49664
    v_mfma_f32_16x16x32_bf16 v[160:163], a[164:167], v[72:75], v[160:163]
    ds_read_b64_tr_b16 v[48:49], v16 offset:53248
    v_mfma_f32_16x16x32_bf16 v[164:167], a[156:159], v[76:79], v[164:167]
    ds_read_b64_tr_b16 v[50:51], v16 offset:53760
    v_mfma_f32_16x16x32_bf16 v[168:171], a[160:163], v[76:79], v[168:171]
    ds_read_b64_tr_b16 v[52:53], v17 offset:53248
    buffer_load_dwordx4 a[24:27], v25, s[16:19], s12 offen sc1
    v_mfma_f32_16x16x32_bf16 v[172:175], a[164:167], v[76:79], v[172:175]
    ds_read_b64_tr_b16 v[54:55], v17 offset:53760
    v_mfma_f32_16x16x32_bf16 v[176:179], a[156:159], v[80:83], v[176:179]
    ds_read_b64_tr_b16 v[56:57], v18 offset:53248
    v_mfma_f32_16x16x32_bf16 v[180:183], a[160:163], v[80:83], v[180:183]
    ds_read_b64_tr_b16 v[58:59], v18 offset:53760
    v_mfma_f32_16x16x32_bf16 v[184:187], a[164:167], v[80:83], v[184:187]
    ds_read_b64_tr_b16 v[60:61], v19 offset:53248
    buffer_load_dwordx4 a[28:31], v26, s[16:19], s12 offen sc1
    s_add_u32 s12, s12, 4096
    v_mfma_f32_16x16x32_bf16 v[188:191], a[156:159], v[84:87], v[188:191]
    ds_read_b64_tr_b16 v[62:63], v19 offset:53760
    v_mfma_f32_16x16x32_bf16 v[192:195], a[160:163], v[84:87], v[192:195]
    v_mfma_f32_16x16x32_bf16 v[196:199], a[164:167], v[84:87], v[196:199]
    buffer_load_dwordx4 a[32:35], v25, s[16:19], s12 offen sc1
    v_mfma_f32_16x16x32_bf16 v[200:203], a[156:159], v[88:91], v[200:203]
    v_mfma_f32_16x16x32_bf16 v[204:207], a[160:163], v[88:91], v[204:207]
    v_mfma_f32_16x16x32_bf16 v[208:211], a[164:167], v[88:91], v[208:211]
    v_mfma_f32_16x16x32_bf16 v[212:215], a[156:159], v[92:95], v[212:215]
    v_mfma_f32_16x16x32_bf16 v[216:219], a[160:163], v[92:95], v[216:219]
    v_mfma_f32_16x16x32_bf16 v[220:223], a[164:167], v[92:95], v[220:223]
    s_waitcnt vmcnt(13) lgkmcnt(0)
    s_barrier
    v_mfma_f32_16x16x32_bf16 v[128:131], a[168:171], v[32:35], v[128:131]
    ds_read_b64_tr_b16 v[64:65], v16 offset:57344
    ds_read_b128 v[96:99], v21 offset:0
    v_mfma_f32_16x16x32_bf16 v[132:135], a[172:175], v[32:35], v[132:135]
    ds_read_b64_tr_b16 v[66:67], v16 offset:57856
    ds_read_b128 v[100:103], v21 offset:64
    v_mfma_f32_16x16x32_bf16 v[136:139], a[176:179], v[32:35], v[136:139]
    ds_read_b64_tr_b16 v[68:69], v17 offset:57344
    buffer_load_dwordx4 a[36:39], v26, s[16:19], s12 offen sc1
    s_add_u32 s12, s12, 4096
    ds_read_b128 v[104:107], v21 offset:128
    v_mfma_f32_16x16x32_bf16 v[140:143], a[168:171], v[36:39], v[140:143]
    ds_read_b64_tr_b16 v[70:71], v17 offset:57856
    ds_read_b128 v[108:111], v21 offset:192
    v_mfma_f32_16x16x32_bf16 v[144:147], a[172:175], v[36:39], v[144:147]
    ds_read_b64_tr_b16 v[72:73], v18 offset:57344
    ds_read_b128 v[112:115], v21 offset:256
    v_mfma_f32_16x16x32_bf16 v[148:151], a[176:179], v[36:39], v[148:151]
    ds_read_b64_tr_b16 v[74:75], v18 offset:57856
    ds_read_b128 v[116:119], v21 offset:320
    v_mfma_f32_16x16x32_bf16 v[152:155], a[168:171], v[40:43], v[152:155]
    ds_read_b64_tr_b16 v[76:77], v19 offset:57344
    buffer_load_dwordx4 a[40:43], v25, s[16:19], s12 offen sc1
    v_mfma_f32_16x16x32_bf16 v[156:159], a[172:175], v[40:43], v[156:159]
    ds_read_b64_tr_b16 v[78:79], v19 offset:57856
    v_mfma_f32_16x16x32_bf16 v[160:163], a[176:179], v[40:43], v[160:163]
    ds_read_b64_tr_b16 v[80:81], v16 offset:61440
    v_mfma_f32_16x16x32_bf16 v[164:167], a[168:171], v[44:47], v[164:167]
    ds_read_b64_tr_b16 v[82:83], v16 offset:61952
    v_mfma_f32_16x16x32_bf16 v[168:171], a[172:175], v[44:47], v[168:171]
    ds_read_b64_tr_b16 v[84:85], v17 offset:61440
    buffer_load_dwordx4 a[44:47], v26, s[16:19], s12 offen sc1
    s_add_u32 s12, s12, 4096
    v_mfma_f32_16x16x32_bf16 v[172:175], a[176:179], v[44:47], v[172:175]
    ds_read_b64_tr_b16 v[86:87], v17 offset:61952
    v_mfma_f32_16x16x32_bf16 v[176:179], a[168:171], v[48:51], v[176:179]
    ds_read_b64_tr_b16 v[88:89], v18 offset:61440
    v_mfma_f32_16x16x32_bf16 v[180:183], a[172:175], v[48:51], v[180:183]
    ds_read_b64_tr_b16 v[90:91], v18 offset:61952
    v_mfma_f32_16x16x32_bf16 v[184:187], a[176:179], v[48:51], v[184:187]
    ds_read_b64_tr_b16 v[92:93], v19 offset:61440
    buffer_load_dwordx4 a[48:51], v25, s[16:19], s12 offen sc1
    v_mfma_f32_16x16x32_bf16 v[188:191], a[168:171], v[52:55], v[188:191]
    ds_read_b64_tr_b16 v[94:95], v19 offset:61952
    v_mfma_f32_16x16x32_bf16 v[192:195], a[172:175], v[52:55], v[192:195]
    v_mfma_f32_16x16x32_bf16 v[196:199], a[176:179], v[52:55], v[196:199]
    buffer_load_dwordx4 a[52:55], v26, s[16:19], s12 offen sc1
    s_add_u32 s12, s12, 4096
    v_mfma_f32_16x16x32_bf16 v[200:203], a[168:171], v[56:59], v[200:203]
    v_mfma_f32_16x16x32_bf16 v[204:207], a[172:175], v[56:59], v[204:207]
    v_mfma_f32_16x16x32_bf16 v[208:211], a[176:179], v[56:59], v[208:211]
    v_mfma_f32_16x16x32_bf16 v[212:215], a[168:171], v[60:63], v[212:215]
    v_mfma_f32_16x16x32_bf16 v[216:219], a[172:175], v[60:63], v[216:219]
    v_mfma_f32_16x16x32_bf16 v[220:223], a[176:179], v[60:63], v[220:223]
    s_waitcnt vmcnt(15) lgkmcnt(0)
    s_nop 0
    v_mfma_f32_16x16x32_bf16 v[128:131], a[180:183], v[64:67], v[128:131]
    v_mfma_f32_16x16x32_bf16 v[132:135], a[184:187], v[64:67], v[132:135]
    v_mfma_f32_16x16x32_bf16 v[136:139], a[188:191], v[64:67], v[136:139]
    buffer_load_dwordx4 a[56:59], v25, s[16:19], s12 offen sc1
    v_mfma_f32_16x16x32_bf16 v[140:143], a[180:183], v[68:71], v[140:143]
    v_mfma_f32_16x16x32_bf16 v[144:147], a[184:187], v[68:71], v[144:147]
    v_mfma_f32_16x16x32_bf16 v[148:151], a[188:191], v[68:71], v[148:151]
    v_mfma_f32_16x16x32_bf16 v[152:155], a[180:183], v[72:75], v[152:155]
    buffer_load_dwordx4 a[60:63], v26, s[16:19], s12 offen sc1
    s_add_u32 s12, s12, 4096
    v_mfma_f32_16x16x32_bf16 v[156:159], a[184:187], v[72:75], v[156:159]
    v_mfma_f32_16x16x32_bf16 v[160:163], a[188:191], v[72:75], v[160:163]
    v_mfma_f32_16x16x32_bf16 v[164:167], a[180:183], v[76:79], v[164:167]
    v_mfma_f32_16x16x32_bf16 v[168:171], a[184:187], v[76:79], v[168:171]
    buffer_load_dwordx4 a[64:67], v25, s[16:19], s12 offen sc1
    v_mfma_f32_16x16x32_bf16 v[172:175], a[188:191], v[76:79], v[172:175]
    v_mfma_f32_16x16x32_bf16 v[176:179], a[180:183], v[80:83], v[176:179]
    v_mfma_f32_16x16x32_bf16 v[180:183], a[184:187], v[80:83], v[180:183]
    v_mfma_f32_16x16x32_bf16 v[184:187], a[188:191], v[80:83], v[184:187]
    buffer_load_dwordx4 a[68:71], v26, s[16:19], s12 offen sc1
    s_add_u32 s12, s12, 4096
    v_mfma_f32_16x16x32_bf16 v[188:191], a[180:183], v[84:87], v[188:191]
    v_mfma_f32_16x16x32_bf16 v[192:195], a[184:187], v[84:87], v[192:195]
    v_mfma_f32_16x16x32_bf16 v[196:199], a[188:191], v[84:87], v[196:199]
    buffer_load_dwordx4 a[72:75], v25, s[16:19], s12 offen sc1
    v_mfma_f32_16x16x32_bf16 v[200:203], a[180:183], v[88:91], v[200:203]
    v_mfma_f32_16x16x32_bf16 v[204:207], a[184:187], v[88:91], v[204:207]
    v_mfma_f32_16x16x32_bf16 v[208:211], a[188:191], v[88:91], v[208:211]
    v_mfma_f32_16x16x32_bf16 v[212:215], a[180:183], v[92:95], v[212:215]
    v_mfma_f32_16x16x32_bf16 v[216:219], a[184:187], v[92:95], v[216:219]
    v_mfma_f32_16x16x32_bf16 v[220:223], a[188:191], v[92:95], v[220:223]
    s_waitcnt vmcnt(14)
    s_mov_b32 s3, 0
K2_poll:
    v_min_u32 v24, v240, v242
    v_cmp_eq_u32 vcc, 0, v24
    s_add_u32 s3, s3, 1
    s_cmp_ge_u32 s3, 0x4000
    s_cbranch_vccz K2_h4
    s_cbranch_scc1 K2_h4
    global_load_dwordx4 v[240:243], v15, s[38:39] sc1
    s_waitcnt vmcnt(0)
    s_branch K2_poll
K2_h4:
    ds_write_b128 v20, v[240:243] offset:1024
    ds_read_b64 v[224:225], v22 offset:1024
    ds_read_b64 v[226:227], v22 offset:1152
    ds_read_b64 v[228:229], v22 offset:1280
    ds_read_b64 v[230:231], v22 offset:1408
    ds_read_b64 v[232:233], v22 offset:1536
    ds_read_b64 v[234:235], v22 offset:1664
    ds_read_b64 v[236:237], v22 offset:1792
    ds_read_b64 v[238:239], v22 offset:1920
    v_mov_b32 v8, 0xbdd2d3e8
    v_mov_b32 v9, 0xc0135761
    v_mov_b32 v10, 1.0
    v_mov_b32 v11, 1.0
    v_bfe_u32 v6, v0, 4, 2
    v_xor_b32 v7, 4, v6
    v_and_b32 v5, 31, v0
    v_lshlrev_b32 v5, 4, v5
    s_mov_b32 s63, 88064
    v_lshrrev_b32 v6, 1, v6
    v_mul_lo_u32 v6, v6, s63
    v_add_u32 v6, v6, v5
    v_lshrrev_b32 v7, 1, v7
    v_mul_lo_u32 v7, v7, s63
    v_add_u32 v7, v7, v5
    s_mul_i32 s46, s40, 352256
    s_lshl_b32 s63, s45, 9
    s_add_u32 s46, s46, s63
    s_waitcnt lgkmcnt(0)
    s_cmp_lt_u32 s45, 172
    s_cselect_b32 s47, s46, 0x10000000
    v_pk_fma_f32 v[32:33], v[96:97], v[224:225], v[100:101] op_sel:[0,1,0] op_sel_hi:[1,1,1]
    v_pk_fma_f32 v[34:35], v[98:99], v[224:225], v[102:103] op_sel:[0,1,0] op_sel_hi:[1,1,1]
    v_pk_fma_f32 v[36:37], v[96:97], v[226:227], v[100:101] op_sel:[0,1,0] op_sel_hi:[1,1,1]
    v_pk_fma_f32 v[38:39], v[98:99], v[226:227], v[102:103] op_sel:[0,1,0] op_sel_hi:[1,1,1]
    v_pk_fma_f32 v[40:41], v[96:97], v[228:229], v[100:101] op_sel:[0,1,0] op_sel_hi:[1,1,1]
    v_pk_fma_f32 v[42:43], v[98:99], v[228:229], v[102:103] op_sel:[0,1,0] op_sel_hi:[1,1,1]
    v_pk_fma_f32 v[44:45], v[96:97], v[230:231], v[100:101] op_sel:[0,1,0] op_sel_hi:[1,1,1]
    v_pk_fma_f32 v[46:47], v[98:99], v[230:231], v[102:103] op_sel:[0,1,0] op_sel_hi:[1,1,1]
    v_pk_fma_f32 v[128:129], v[128:129], v[224:225], v[32:33] op_sel:[0,0,0] op_sel_hi:[1,0,1]
    v_pk_fma_f32 v[130:131], v[130:131], v[224:225], v[34:35] op_sel:[0,0,0] op_sel_hi:[1,0,1]
    v_pk_fma_f32 v[140:141], v[140:141], v[226:227], v[36:37] op_sel:[0,0,0] op_sel_hi:[1,0,1]
    v_pk_fma_f32 v[142:143], v[142:143], v[226:227], v[38:39] op_sel:[0,0,0] op_sel_hi:[1,0,1]
    v_pk_fma_f32 v[152:153], v[152:153], v[228:229], v[40:41] op_sel:[0,0,0] op_sel_hi:[1,0,1]
    v_pk_fma_f32 v[154:155], v[154:155], v[228:229], v[42:43] op_sel:[0,0,0] op_sel_hi:[1,0,1]
    v_pk_fma_f32 v[164:165], v[164:165], v[230:231], v[44:45] op_sel:[0,0,0] op_sel_hi:[1,0,1]
    v_pk_fma_f32 v[166:167], v[166:167], v[230:231], v[46:47] op_sel:[0,0,0] op_sel_hi:[1,0,1]
    buffer_load_dwordx4 a[76:79], v26, s[16:19], s12 offen sc1
    s_add_u32 s12, s12, 4096
    v_pk_mul_f32 v[32:33], v[128:129], v[128:129]
    v_pk_mul_f32 v[36:37], v[140:141], v[140:141]
    v_pk_mul_f32 v[40:41], v[152:153], v[152:153]
    v_pk_mul_f32 v[44:45], v[164:165], v[164:165]
    v_pk_fma_f32 v[32:33], v[32:33], v[8:9], v[8:9] op_sel:[0,0,1] op_sel_hi:[1,0,1]
    v_pk_fma_f32 v[36:37], v[36:37], v[8:9], v[8:9] op_sel:[0,0,1] op_sel_hi:[1,0,1]
    v_pk_fma_f32 v[40:41], v[40:41], v[8:9], v[8:9] op_sel:[0,0,1] op_sel_hi:[1,0,1]
    v_pk_fma_f32 v[44:45], v[44:45], v[8:9], v[8:9] op_sel:[0,0,1] op_sel_hi:[1,0,1]
    v_pk_mul_f32 v[32:33], v[32:33], v[128:129]
    v_pk_mul_f32 v[36:37], v[36:37], v[140:141]
    v_pk_mul_f32 v[40:41], v[40:41], v[152:153]
    v_pk_mul_f32 v[44:45], v[44:45], v[164:165]
    buffer_load_dwordx4 a[80:83], v25, s[16:19], s12 offen sc1
    v_exp_f32 v32, v32
    v_exp_f32 v33, v33
    v_exp_f32 v36, v36
    v_exp_f32 v37, v37
    v_exp_f32 v40, v40
    v_exp_f32 v41, v41
    v_exp_f32 v44, v44
    v_exp_f32 v45, v45
    buffer_load_dwordx4 a[84:87], v26, s[16:19], s12 offen sc1
    s_add_u32 s12, s12, 4096
    v_pk_mul_f32 v[128:129], v[128:129], v[130:131]
    v_pk_mul_f32 v[140:141], v[140:141], v[142:143]
    v_pk_mul_f32 v[152:153], v[152:153], v[154:155]
    v_pk_mul_f32 v[164:165], v[164:165], v[166:167]
    v_pk_add_f32 v[32:33], v[32:33], v[10:11]
    v_pk_add_f32 v[36:37], v[36:37], v[10:11]
    v_pk_add_f32 v[40:41], v[40:41], v[10:11]
    v_pk_add_f32 v[44:45], v[44:45], v[10:11]
    buffer_load_dwordx4 a[88:91], v25, s[16:19], s12 offen sc1
    v_rcp_f32 v32, v32
    v_rcp_f32 v33, v33
    v_rcp_f32 v36, v36
    v_rcp_f32 v37, v37
    v_rcp_f32 v40, v40
    v_rcp_f32 v41, v41
    v_rcp_f32 v44, v44
    v_rcp_f32 v45, v45
    buffer_load_dwordx4 a[92:95], v26, s[16:19], s12 offen sc1
    s_add_u32 s12, s12, 4096
    v_pk_mul_f32 v[128:129], v[128:129], v[32:33]
    v_pk_mul_f32 v[140:141], v[140:141], v[36:37]
    v_pk_mul_f32 v[152:153], v[152:153], v[40:41]
    v_pk_mul_f32 v[164:165], v[164:165], v[44:45]
    v_cvt_pk_bf16_f32 v64, v128, v129
    v_cvt_pk_bf16_f32 v65, v140, v141
    v_cvt_pk_bf16_f32 v66, v152, v153
    v_cvt_pk_bf16_f32 v67, v164, v165
    s_nop 0
    v_permlane32_swap_b32 v64, v66
    v_permlane32_swap_b32 v65, v67
    s_nop 1
    v_permlane16_swap_b32 v64, v65
    v_permlane16_swap_b32 v66, v67
    buffer_store_dwordx4 v[64:67], v6, s[20:23], s47 offen offset:0 sc1
    v_pk_fma_f32 v[48:49], v[96:97], v[232:233], v[100:101] op_sel:[0,1,0] op_sel_hi:[1,1,1]
    v_pk_fma_f32 v[50:51], v[98:99], v[232:233], v[102:103] op_sel:[0,1,0] op_sel_hi:[1,1,1]
    v_pk_fma_f32 v[52:53], v[96:97], v[234:235], v[100:101] op_sel:[0,1,0] op_sel_hi:[1,1,1]
    v_pk_fma_f32 v[54:55], v[98:99], v[234:235], v[102:103] op_sel:[0,1,0] op_sel_hi:[1,1,1]
    v_pk_fma_f32 v[56:57], v[96:97], v[236:237], v[100:101] op_sel:[0,1,0] op_sel_hi:[1,1,1]
    v_pk_fma_f32 v[58:59], v[98:99], v[236:237], v[102:103] op_sel:[0,1,0] op_sel_hi:[1,1,1]
    v_pk_fma_f32 v[60:61], v[96:97], v[238:239], v[100:101] op_sel:[0,1,0] op_sel_hi:[1,1,1]
    v_pk_fma_f32 v[62:63], v[98:99], v[238:239], v[102:103] op_sel:[0,1,0] op_sel_hi:[1,1,1]
    v_pk_fma_f32 v[176:177], v[176:177], v[232:233], v[48:49] op_sel:[0,0,0] op_sel_hi:[1,0,1]
    v_pk_fma_f32 v[178:179], v[178:179], v[232:233], v[50:51] op_sel:[0,0,0] op_sel_hi:[1,0,1]
    v_pk_fma_f32 v[188:189], v[188:189], v[234:235], v[52:53] op_sel:[0,0,0] op_sel_hi:[1,0,1]
    v_pk_fma_f32 v[190:191], v[190:191], v[234:235], v[54:55] op_sel:[0,0,0] op_sel_hi:[1,0,1]
    v_pk_fma_f32 v[200:201], v[200:201], v[236:237], v[56:57] op_sel:[0,0,0] op_sel_hi:[1,0,1]
    v_pk_fma_f32 v[202:203], v[202:203], v[236:237], v[58:59] op_sel:[0,0,0] op_sel_hi:[1,0,1]
    v_pk_fma_f32 v[212:213], v[212:213], v[238:239], v[60:61] op_sel:[0,0,0] op_sel_hi:[1,0,1]
    v_pk_fma_f32 v[214:215], v[214:215], v[238:239], v[62:63] op_sel:[0,0,0] op_sel_hi:[1,0,1]
    buffer_load_dwordx4 a[96:99], v25, s[16:19], s12 offen sc1
    v_pk_mul_f32 v[48:49], v[176:177], v[176:177]
    v_pk_mul_f32 v[52:53], v[188:189], v[188:189]
    v_pk_mul_f32 v[56:57], v[200:201], v[200:201]
    v_pk_mul_f32 v[60:61], v[212:213], v[212:213]
    v_pk_fma_f32 v[48:49], v[48:49], v[8:9], v[8:9] op_sel:[0,0,1] op_sel_hi:[1,0,1]
    v_pk_fma_f32 v[52:53], v[52:53], v[8:9], v[8:9] op_sel:[0,0,1] op_sel_hi:[1,0,1]
    v_pk_fma_f32 v[56:57], v[56:57], v[8:9], v[8:9] op_sel:[0,0,1] op_sel_hi:[1,0,1]
    v_pk_fma_f32 v[60:61], v[60:61], v[8:9], v[8:9] op_sel:[0,0,1] op_sel_hi:[1,0,1]
    v_pk_mul_f32 v[48:49], v[48:49], v[176:177]
    v_pk_mul_f32 v[52:53], v[52:53], v[188:189]
    v_pk_mul_f32 v[56:57], v[56:57], v[200:201]
    v_pk_mul_f32 v[60:61], v[60:61], v[212:213]
    buffer_load_dwordx4 a[100:103], v26, s[16:19], s12 offen sc1
    s_add_u32 s12, s12, 4096
    v_exp_f32 v48, v48
    v_exp_f32 v49, v49
    v_exp_f32 v52, v52
    v_exp_f32 v53, v53
    v_exp_f32 v56, v56
    v_exp_f32 v57, v57
    v_exp_f32 v60, v60
    v_exp_f32 v61, v61
    buffer_load_dwordx4 a[104:107], v25, s[16:19], s12 offen sc1
    v_pk_mul_f32 v[176:177], v[176:177], v[178:179]
    v_pk_mul_f32 v[188:189], v[188:189], v[190:191]
    v_pk_mul_f32 v[200:201], v[200:201], v[202:203]
    v_pk_mul_f32 v[212:213], v[212:213], v[214:215]
    v_pk_add_f32 v[48:49], v[48:49], v[10:11]
    v_pk_add_f32 v[52:53], v[52:53], v[10:11]
    v_pk_add_f32 v[56:57], v[56:57], v[10:11]
    v_pk_add_f32 v[60:61], v[60:61], v[10:11]
    buffer_load_dwordx4 a[108:111], v26, s[16:19], s12 offen sc1
    s_add_u32 s12, s12, 4096
    v_rcp_f32 v48, v48
    v_rcp_f32 v49, v49
    v_rcp_f32 v52, v52
    v_rcp_f32 v53, v53
    v_rcp_f32 v56, v56
    v_rcp_f32 v57, v57
    v_rcp_f32 v60, v60
    v_rcp_f32 v61, v61
    buffer_load_dwordx4 a[112:115], v25, s[16:19], s12 offen sc1
    v_pk_mul_f32 v[176:177], v[176:177], v[48:49]
    v_pk_mul_f32 v[188:189], v[188:189], v[52:53]
    v_pk_mul_f32 v[200:201], v[200:201], v[56:57]
    v_pk_mul_f32 v[212:213], v[212:213], v[60:61]
    v_cvt_pk_bf16_f32 v68, v176, v177
    v_cvt_pk_bf16_f32 v69, v188, v189
    v_cvt_pk_bf16_f32 v70, v200, v201
    v_cvt_pk_bf16_f32 v71, v212, v213
    s_nop 0
    v_permlane32_swap_b32 v68, v70
    v_permlane32_swap_b32 v69, v71
    s_nop 1
    v_permlane16_swap_b32 v68, v69
    v_permlane16_swap_b32 v70, v71
    buffer_store_dwordx4 v[68:71], v7, s[20:23], s47 offen offset:0 sc1
    s_cmp_lt_u32 s45, 171
    s_cselect_b32 s47, s46, 0x10000000
    v_pk_fma_f32 v[32:33], v[104:105], v[224:225], v[108:109] op_sel:[0,1,0] op_sel_hi:[1,1,1]
    v_pk_fma_f32 v[34:35], v[106:107], v[224:225], v[110:111] op_sel:[0,1,0] op_sel_hi:[1,1,1]
    v_pk_fma_f32 v[36:37], v[104:105], v[226:227], v[108:109] op_sel:[0,1,0] op_sel_hi:[1,1,1]
    v_pk_fma_f32 v[38:39], v[106:107], v[226:227], v[110:111] op_sel:[0,1,0] op_sel_hi:[1,1,1]
    v_pk_fma_f32 v[40:41], v[104:105], v[228:229], v[108:109] op_sel:[0,1,0] op_sel_hi:[1,1,1]
    v_pk_fma_f32 v[42:43], v[106:107], v[228:229], v[110:111] op_sel:[0,1,0] op_sel_hi:[1,1,1]
    v_pk_fma_f32 v[44:45], v[104:105], v[230:231], v[108:109] op_sel:[0,1,0] op_sel_hi:[1,1,1]
    v_pk_fma_f32 v[46:47], v[106:107], v[230:231], v[110:111] op_sel:[0,1,0] op_sel_hi:[1,1,1]
    v_pk_fma_f32 v[132:133], v[132:133], v[224:225], v[32:33] op_sel:[0,0,0] op_sel_hi:[1,0,1]
    v_pk_fma_f32 v[134:135], v[134:135], v[224:225], v[34:35] op_sel:[0,0,0] op_sel_hi:[1,0,1]
    v_pk_fma_f32 v[144:145], v[144:145], v[226:227], v[36:37] op_sel:[0,0,0] op_sel_hi:[1,0,1]
    v_pk_fma_f32 v[146:147], v[146:147], v[226:227], v[38:39] op_sel:[0,0,0] op_sel_hi:[1,0,1]
    v_pk_fma_f32 v[156:157], v[156:157], v[228:229], v[40:41] op_sel:[0,0,0] op_sel_hi:[1,0,1]
    v_pk_fma_f32 v[158:159], v[158:159], v[228:229], v[42:43] op_sel:[0,0,0] op_sel_hi:[1,0,1]
    v_pk_fma_f32 v[168:169], v[168:169], v[230:231], v[44:45] op_sel:[0,0,0] op_sel_hi:[1,0,1]
    v_pk_fma_f32 v[170:171], v[170:171], v[230:231], v[46:47] op_sel:[0,0,0] op_sel_hi:[1,0,1]
    buffer_load_dwordx4 a[116:119], v26, s[16:19], s12 offen sc1
    s_add_u32 s12, s12, 4096
    v_pk_mul_f32 v[32:33], v[132:133], v[132:133]
    v_pk_mul_f32 v[36:37], v[144:145], v[144:145]
    v_pk_mul_f32 v[40:41], v[156:157], v[156:157]
    v_pk_mul_f32 v[44:45], v[168:169], v[168:169]
    v_pk_fma_f32 v[32:33], v[32:33], v[8:9], v[8:9] op_sel:[0,0,1] op_sel_hi:[1,0,1]
    v_pk_fma_f32 v[36:37], v[36:37], v[8:9], v[8:9] op_sel:[0,0,1] op_sel_hi:[1,0,1]
    v_pk_fma_f32 v[40:41], v[40:41], v[8:9], v[8:9] op_sel:[0,0,1] op_sel_hi:[1,0,1]
    v_pk_fma_f32 v[44:45], v[44:45], v[8:9], v[8:9] op_sel:[0,0,1] op_sel_hi:[1,0,1]
    v_pk_mul_f32 v[32:33], v[32:33], v[132:133]
    v_pk_mul_f32 v[36:37], v[36:37], v[144:145]
    v_pk_mul_f32 v[40:41], v[40:41], v[156:157]
    v_pk_mul_f32 v[44:45], v[44:45], v[168:169]
    buffer_load_dwordx4 a[120:123], v25, s[16:19], s12 offen sc1
    v_exp_f32 v32, v32
    v_exp_f32 v33, v33
    v_exp_f32 v36, v36
    v_exp_f32 v37, v37
    v_exp_f32 v40, v40
    v_exp_f32 v41, v41
    v_exp_f32 v44, v44
    v_exp_f32 v45, v45
    buffer_load_dwordx4 a[124:127], v26, s[16:19], s12 offen sc1
    s_add_u32 s12, s12, 4096
    v_pk_mul_f32 v[132:133], v[132:133], v[134:135]
    v_pk_mul_f32 v[144:145], v[144:145], v[146:147]
    v_pk_mul_f32 v[156:157], v[156:157], v[158:159]
    v_pk_mul_f32 v[168:169], v[168:169], v[170:171]
    v_pk_add_f32 v[32:33], v[32:33], v[10:11]
    v_pk_add_f32 v[36:37], v[36:37], v[10:11]
    v_pk_add_f32 v[40:41], v[40:41], v[10:11]
    v_pk_add_f32 v[44:45], v[44:45], v[10:11]
    buffer_load_dwordx4 a[128:131], v25, s[16:19], s12 offen sc1
    v_rcp_f32 v32, v32
    v_rcp_f32 v33, v33
    v_rcp_f32 v36, v36
    v_rcp_f32 v37, v37
    v_rcp_f32 v40, v40
    v_rcp_f32 v41, v41
    v_rcp_f32 v44, v44
    v_rcp_f32 v45, v45
    buffer_load_dwordx4 a[132:135], v26, s[16:19], s12 offen sc1
    s_add_u32 s12, s12, 4096
    v_pk_mul_f32 v[132:133], v[132:133], v[32:33]
    v_pk_mul_f32 v[144:145], v[144:145], v[36:37]
    v_pk_mul_f32 v[156:157], v[156:157], v[40:41]
    v_pk_mul_f32 v[168:169], v[168:169], v[44:45]
    v_cvt_pk_bf16_f32 v72, v132, v133
    v_cvt_pk_bf16_f32 v73, v144, v145
    v_cvt_pk_bf16_f32 v74, v156, v157
    v_cvt_pk_bf16_f32 v75, v168, v169
    s_nop 0
    v_permlane32_swap_b32 v72, v74
    v_permlane32_swap_b32 v73, v75
    s_nop 1
    v_permlane16_swap_b32 v72, v73
    v_permlane16_swap_b32 v74, v75
    buffer_store_dwordx4 v[72:75], v6, s[20:23], s47 offen offset:512 sc1
    v_pk_fma_f32 v[48:49], v[104:105], v[232:233], v[108:109] op_sel:[0,1,0] op_sel_hi:[1,1,1]
    v_pk_fma_f32 v[50:51], v[106:107], v[232:233], v[110:111] op_sel:[0,1,0] op_sel_hi:[1,1,1]
    v_pk_fma_f32 v[52:53], v[104:105], v[234:235], v[108:109] op_sel:[0,1,0] op_sel_hi:[1,1,1]
    v_pk_fma_f32 v[54:55], v[106:107], v[234:235], v[110:111] op_sel:[0,1,0] op_sel_hi:[1,1,1]
    v_pk_fma_f32 v[56:57], v[104:105], v[236:237], v[108:109] op_sel:[0,1,0] op_sel_hi:[1,1,1]
    v_pk_fma_f32 v[58:59], v[106:107], v[236:237], v[110:111] op_sel:[0,1,0] op_sel_hi:[1,1,1]
    v_pk_fma_f32 v[60:61], v[104:105], v[238:239], v[108:109] op_sel:[0,1,0] op_sel_hi:[1,1,1]
    v_pk_fma_f32 v[62:63], v[106:107], v[238:239], v[110:111] op_sel:[0,1,0] op_sel_hi:[1,1,1]
    v_pk_fma_f32 v[180:181], v[180:181], v[232:233], v[48:49] op_sel:[0,0,0] op_sel_hi:[1,0,1]
    v_pk_fma_f32 v[182:183], v[182:183], v[232:233], v[50:51] op_sel:[0,0,0] op_sel_hi:[1,0,1]
    v_pk_fma_f32 v[192:193], v[192:193], v[234:235], v[52:53] op_sel:[0,0,0] op_sel_hi:[1,0,1]
    v_pk_fma_f32 v[194:195], v[194:195], v[234:235], v[54:55] op_sel:[0,0,0] op_sel_hi:[1,0,1]
    v_pk_fma_f32 v[204:205], v[204:205], v[236:237], v[56:57] op_sel:[0,0,0] op_sel_hi:[1,0,1]
    v_pk_fma_f32 v[206:207], v[206:207], v[236:237], v[58:59] op_sel:[0,0,0] op_sel_hi:[1,0,1]
    v_pk_fma_f32 v[216:217], v[216:217], v[238:239], v[60:61] op_sel:[0,0,0] op_sel_hi:[1,0,1]
    v_pk_fma_f32 v[218:219], v[218:219], v[238:239], v[62:63] op_sel:[0,0,0] op_sel_hi:[1,0,1]
    buffer_load_dwordx4 a[136:139], v25, s[16:19], s12 offen sc1
    v_pk_mul_f32 v[48:49], v[180:181], v[180:181]
    v_pk_mul_f32 v[52:53], v[192:193], v[192:193]
    v_pk_mul_f32 v[56:57], v[204:205], v[204:205]
    v_pk_mul_f32 v[60:61], v[216:217], v[216:217]
    v_pk_fma_f32 v[48:49], v[48:49], v[8:9], v[8:9] op_sel:[0,0,1] op_sel_hi:[1,0,1]
    v_pk_fma_f32 v[52:53], v[52:53], v[8:9], v[8:9] op_sel:[0,0,1] op_sel_hi:[1,0,1]
    v_pk_fma_f32 v[56:57], v[56:57], v[8:9], v[8:9] op_sel:[0,0,1] op_sel_hi:[1,0,1]
    v_pk_fma_f32 v[60:61], v[60:61], v[8:9], v[8:9] op_sel:[0,0,1] op_sel_hi:[1,0,1]
    v_pk_mul_f32 v[48:49], v[48:49], v[180:181]
    v_pk_mul_f32 v[52:53], v[52:53], v[192:193]
    v_pk_mul_f32 v[56:57], v[56:57], v[204:205]
    v_pk_mul_f32 v[60:61], v[60:61], v[216:217]
    buffer_load_dwordx4 a[140:143], v26, s[16:19], s12 offen sc1
    s_add_u32 s12, s12, 4096
    v_exp_f32 v48, v48
    v_exp_f32 v49, v49
    v_exp_f32 v52, v52
    v_exp_f32 v53, v53
    v_exp_f32 v56, v56
    v_exp_f32 v57, v57
    v_exp_f32 v60, v60
    v_exp_f32 v61, v61
    buffer_load_dwordx4 a[144:147], v25, s[16:19], s12 offen sc1
    v_pk_mul_f32 v[180:181], v[180:181], v[182:183]
    v_pk_mul_f32 v[192:193], v[192:193], v[194:195]
    v_pk_mul_f32 v[204:205], v[204:205], v[206:207]
    v_pk_mul_f32 v[216:217], v[216:217], v[218:219]
    v_pk_add_f32 v[48:49], v[48:49], v[10:11]
    v_pk_add_f32 v[52:53], v[52:53], v[10:11]
    v_pk_add_f32 v[56:57], v[56:57], v[10:11]
    v_pk_add_f32 v[60:61], v[60:61], v[10:11]
    buffer_load_dwordx4 a[148:151], v26, s[16:19], s12 offen sc1
    s_add_u32 s12, s12, 4096
    v_rcp_f32 v48, v48
    v_rcp_f32 v49, v49
    v_rcp_f32 v52, v52
    v_rcp_f32 v53, v53
    v_rcp_f32 v56, v56
    v_rcp_f32 v57, v57
    v_rcp_f32 v60, v60
    v_rcp_f32 v61, v61
    buffer_load_dwordx4 a[152:155], v25, s[16:19], s12 offen sc1
    v_pk_mul_f32 v[180:181], v[180:181], v[48:49]
    v_pk_mul_f32 v[192:193], v[192:193], v[52:53]
    v_pk_mul_f32 v[204:205], v[204:205], v[56:57]
    v_pk_mul_f32 v[216:217], v[216:217], v[60:61]
    v_cvt_pk_bf16_f32 v76, v180, v181
    v_cvt_pk_bf16_f32 v77, v192, v193
    v_cvt_pk_bf16_f32 v78, v204, v205
    v_cvt_pk_bf16_f32 v79, v216, v217
    s_nop 0
    v_permlane32_swap_b32 v76, v78
    v_permlane32_swap_b32 v77, v79
    s_nop 1
    v_permlane16_swap_b32 v76, v77
    v_permlane16_swap_b32 v78, v79
    buffer_store_dwordx4 v[76:79], v7, s[20:23], s47 offen offset:512 sc1
    s_cmp_lt_u32 s45, 170
    s_cselect_b32 s47, s46, 0x10000000
    v_pk_fma_f32 v[32:33], v[112:113], v[224:225], v[116:117] op_sel:[0,1,0] op_sel_hi:[1,1,1]
    v_pk_fma_f32 v[34:35], v[114:115], v[224:225], v[118:119] op_sel:[0,1,0] op_sel_hi:[1,1,1]
    v_pk_fma_f32 v[36:37], v[112:113], v[226:227], v[116:117] op_sel:[0,1,0] op_sel_hi:[1,1,1]
    v_pk_fma_f32 v[38:39], v[114:115], v[226:227], v[118:119] op_sel:[0,1,0] op_sel_hi:[1,1,1]
    v_pk_fma_f32 v[40:41], v[112:113], v[228:229], v[116:117] op_sel:[0,1,0] op_sel_hi:[1,1,1]
    v_pk_fma_f32 v[42:43], v[114:115], v[228:229], v[118:119] op_sel:[0,1,0] op_sel_hi:[1,1,1]
    v_pk_fma_f32 v[44:45], v[112:113], v[230:231], v[116:117] op_sel:[0,1,0] op_sel_hi:[1,1,1]
    v_pk_fma_f32 v[46:47], v[114:115], v[230:231], v[118:119] op_sel:[0,1,0] op_sel_hi:[1,1,1]
    v_pk_fma_f32 v[136:137], v[136:137], v[224:225], v[32:33] op_sel:[0,0,0] op_sel_hi:[1,0,1]
    v_pk_fma_f32 v[138:139], v[138:139], v[224:225], v[34:35] op_sel:[0,0,0] op_sel_hi:[1,0,1]
    v_pk_fma_f32 v[148:149], v[148:149], v[226:227], v[36:37] op_sel:[0,0,0] op_sel_hi:[1,0,1]
    v_pk_fma_f32 v[150:151], v[150:151], v[226:227], v[38:39] op_sel:[0,0,0] op_sel_hi:[1,0,1]
    v_pk_fma_f32 v[160:161], v[160:161], v[228:229], v[40:41] op_sel:[0,0,0] op_sel_hi:[1,0,1]
    v_pk_fma_f32 v[162:163], v[162:163], v[228:229], v[42:43] op_sel:[0,0,0] op_sel_hi:[1,0,1]
    v_pk_fma_f32 v[172:173], v[172:173], v[230:231], v[44:45] op_sel:[0,0,0] op_sel_hi:[1,0,1]
    v_pk_fma_f32 v[174:175], v[174:175], v[230:231], v[46:47] op_sel:[0,0,0] op_sel_hi:[1,0,1]
    buffer_load_dwordx4 a[156:159], v26, s[16:19], s12 offen sc1
    s_add_u32 s12, s12, 4096
    v_pk_mul_f32 v[32:33], v[136:137], v[136:137]
    v_pk_mul_f32 v[36:37], v[148:149], v[148:149]
    v_pk_mul_f32 v[40:41], v[160:161], v[160:161]
    v_pk_mul_f32 v[44:45], v[172:173], v[172:173]
    v_pk_fma_f32 v[32:33], v[32:33], v[8:9], v[8:9] op_sel:[0,0,1] op_sel_hi:[1,0,1]
    v_pk_fma_f32 v[36:37], v[36:37], v[8:9], v[8:9] op_sel:[0,0,1] op_sel_hi:[1,0,1]
    v_pk_fma_f32 v[40:41], v[40:41], v[8:9], v[8:9] op_sel:[0,0,1] op_sel_hi:[1,0,1]
    v_pk_fma_f32 v[44:45], v[44:45], v[8:9], v[8:9] op_sel:[0,0,1] op_sel_hi:[1,0,1]
    v_pk_mul_f32 v[32:33], v[32:33], v[136:137]
    v_pk_mul_f32 v[36:37], v[36:37], v[148:149]
    v_pk_mul_f32 v[40:41], v[40:41], v[160:161]
    v_pk_mul_f32 v[44:45], v[44:45], v[172:173]
    buffer_load_dwordx4 a[160:163], v25, s[16:19], s12 offen sc1
    v_exp_f32 v32, v32
    v_exp_f32 v33, v33
    v_exp_f32 v36, v36
    v_exp_f32 v37, v37
    v_exp_f32 v40, v40
    v_exp_f32 v41, v41
    v_exp_f32 v44, v44
    v_exp_f32 v45, v45
    buffer_load_dwordx4 a[164:167], v26, s[16:19], s12 offen sc1
    s_add_u32 s12, s12, 4096
    v_pk_mul_f32 v[136:137], v[136:137], v[138:139]
    v_pk_mul_f32 v[148:149], v[148:149], v[150:151]
    v_pk_mul_f32 v[160:161], v[160:161], v[162:163]
    v_pk_mul_f32 v[172:173], v[172:173], v[174:175]
    v_pk_add_f32 v[32:33], v[32:33], v[10:11]
    v_pk_add_f32 v[36:37], v[36:37], v[10:11]
    v_pk_add_f32 v[40:41], v[40:41], v[10:11]
    v_pk_add_f32 v[44:45], v[44:45], v[10:11]
    buffer_load_dwordx4 a[168:171], v25, s[16:19], s24 offen sc1
    v_rcp_f32 v32, v32
    v_rcp_f32 v33, v33
    v_rcp_f32 v36, v36
    v_rcp_f32 v37, v37
    v_rcp_f32 v40, v40
    v_rcp_f32 v41, v41
    v_rcp_f32 v44, v44
    v_rcp_f32 v45, v45
    buffer_load_dwordx4 a[172:175], v26, s[16:19], s24 offen sc1
    s_add_u32 s12, s12, 4096
    v_pk_mul_f32 v[136:137], v[136:137], v[32:33]
    v_pk_mul_f32 v[148:149], v[148:149], v[36:37]
    v_pk_mul_f32 v[160:161], v[160:161], v[40:41]
    v_pk_mul_f32 v[172:173], v[172:173], v[44:45]
    v_cvt_pk_bf16_f32 v80, v136, v137
    v_cvt_pk_bf16_f32 v81, v148, v149
    v_cvt_pk_bf16_f32 v82, v160, v161
    v_cvt_pk_bf16_f32 v83, v172, v173
    s_nop 0
    v_permlane32_swap_b32 v80, v82
    v_permlane32_swap_b32 v81, v83
    s_nop 1
    v_permlane16_swap_b32 v80, v81
    v_permlane16_swap_b32 v82, v83
    buffer_store_dwordx4 v[80:83], v6, s[20:23], s47 offen offset:1024 sc1
    v_pk_fma_f32 v[48:49], v[112:113], v[232:233], v[116:117] op_sel:[0,1,0] op_sel_hi:[1,1,1]
    v_pk_fma_f32 v[50:51], v[114:115], v[232:233], v[118:119] op_sel:[0,1,0] op_sel_hi:[1,1,1]
    v_pk_fma_f32 v[52:53], v[112:113], v[234:235], v[116:117] op_sel:[0,1,0] op_sel_hi:[1,1,1]
    v_pk_fma_f32 v[54:55], v[114:115], v[234:235], v[118:119] op_sel:[0,1,0] op_sel_hi:[1,1,1]
    v_pk_fma_f32 v[56:57], v[112:113], v[236:237], v[116:117] op_sel:[0,1,0] op_sel_hi:[1,1,1]
    v_pk_fma_f32 v[58:59], v[114:115], v[236:237], v[118:119] op_sel:[0,1,0] op_sel_hi:[1,1,1]
    v_pk_fma_f32 v[60:61], v[112:113], v[238:239], v[116:117] op_sel:[0,1,0] op_sel_hi:[1,1,1]
    v_pk_fma_f32 v[62:63], v[114:115], v[238:239], v[118:119] op_sel:[0,1,0] op_sel_hi:[1,1,1]
    v_pk_fma_f32 v[184:185], v[184:185], v[232:233], v[48:49] op_sel:[0,0,0] op_sel_hi:[1,0,1]
    v_pk_fma_f32 v[186:187], v[186:187], v[232:233], v[50:51] op_sel:[0,0,0] op_sel_hi:[1,0,1]
    v_pk_fma_f32 v[196:197], v[196:197], v[234:235], v[52:53] op_sel:[0,0,0] op_sel_hi:[1,0,1]
    v_pk_fma_f32 v[198:199], v[198:199], v[234:235], v[54:55] op_sel:[0,0,0] op_sel_hi:[1,0,1]
    v_pk_fma_f32 v[208:209], v[208:209], v[236:237], v[56:57] op_sel:[0,0,0] op_sel_hi:[1,0,1]
    v_pk_fma_f32 v[210:211], v[210:211], v[236:237], v[58:59] op_sel:[0,0,0] op_sel_hi:[1,0,1]
    v_pk_fma_f32 v[220:221], v[220:221], v[238:239], v[60:61] op_sel:[0,0,0] op_sel_hi:[1,0,1]
    v_pk_fma_f32 v[222:223], v[222:223], v[238:239], v[62:63] op_sel:[0,0,0] op_sel_hi:[1,0,1]
    v_pk_mul_f32 v[48:49], v[184:185], v[184:185]
    v_pk_mul_f32 v[52:53], v[196:197], v[196:197]
    v_pk_mul_f32 v[56:57], v[208:209], v[208:209]
    v_pk_mul_f32 v[60:61], v[220:221], v[220:221]
    v_pk_fma_f32 v[48:49], v[48:49], v[8:9], v[8:9] op_sel:[0,0,1] op_sel_hi:[1,0,1]
    v_pk_fma_f32 v[52:53], v[52:53], v[8:9], v[8:9] op_sel:[0,0,1] op_sel_hi:[1,0,1]
    v_pk_fma_f32 v[56:57], v[56:57], v[8:9], v[8:9] op_sel:[0,0,1] op_sel_hi:[1,0,1]
    v_pk_fma_f32 v[60:61], v[60:61], v[8:9], v[8:9] op_sel:[0,0,1] op_sel_hi:[1,0,1]
    v_pk_mul_f32 v[48:49], v[48:49], v[184:185]
    v_pk_mul_f32 v[52:53], v[52:53], v[196:197]
    v_pk_mul_f32 v[56:57], v[56:57], v[208:209]
    v_pk_mul_f32 v[60:61], v[60:61], v[220:221]
    v_exp_f32 v48, v48
    v_exp_f32 v49, v49
    v_exp_f32 v52, v52
    v_exp_f32 v53, v53
    v_exp_f32 v56, v56
    v_exp_f32 v57, v57
    v_exp_f32 v60, v60
    v_exp_f32 v61, v61
    v_pk_mul_f32 v[184:185], v[184:185], v[186:187]
    v_pk_mul_f32 v[196:197], v[196:197], v[198:199]
    v_pk_mul_f32 v[208:209], v[208:209], v[210:211]
    v_pk_mul_f32 v[220:221], v[220:221], v[222:223]
    v_pk_add_f32 v[48:49], v[48:49], v[10:11]
    v_pk_add_f32 v[52:53], v[52:53], v[10:11]
    v_pk_add_f32 v[56:57], v[56:57], v[10:11]
    v_pk_add_f32 v[60:61], v[60:61], v[10:11]
    v_rcp_f32 v48, v48
    v_rcp_f32 v49, v49
    v_rcp_f32 v52, v52
    v_rcp_f32 v53, v53
    v_rcp_f32 v56, v56
    v_rcp_f32 v57, v57
    v_rcp_f32 v60, v60
    v_rcp_f32 v61, v61
    v_pk_mul_f32 v[184:185], v[184:185], v[48:49]
    v_pk_mul_f32 v[196:197], v[196:197], v[52:53]
    v_pk_mul_f32 v[208:209], v[208:209], v[56:57]
    v_pk_mul_f32 v[220:221], v[220:221], v[60:61]
    v_cvt_pk_bf16_f32 v84, v184, v185
    v_cvt_pk_bf16_f32 v85, v196, v197
    v_cvt_pk_bf16_f32 v86, v208, v209
    v_cvt_pk_bf16_f32 v87, v220, v221
    s_nop 0
    v_permlane32_swap_b32 v84, v86
    v_permlane32_swap_b32 v85, v87
    s_nop 1
    v_permlane16_swap_b32 v84, v85
    v_permlane16_swap_b32 v86, v87
    buffer_store_dwordx4 v[84:87], v7, s[20:23], s47 offen offset:1024 sc1
    s_lshl_b32 s63, s8, 16
    s_lshl_b32 s64, s10, 12
    s_add_u32 s63, s63, s64
    s_lshl_b32 s64, s15, 6
    s_add_u32 s63, s63, s64
    v_bfe_u32 v6, v0, 2, 4
    v_lshlrev_b32 v6, 7, v6
    v_and_b32 v7, 3, v0
    v_lshl_add_u32 v7, v7, 4, v6
    s_add_u32 m0, s60, 131072
    s_lshl_b32 s65, s10, 7
    s_add_u32 s65, s65, 0x28a800
    buffer_load_dwordx4 v7, s[48:51], s63 offen sc1 lds
    s_add_u32 s63, s63, 1024
    buffer_load_dwordx4 v7, s[48:51], s63 offen offset:1024 sc1 lds
    v_bfe_u32 v6, v0, 5, 1
    v_lshl_add_u32 v7, v6, 5, s65
    global_load_dwordx4 v[224:227], v7, s[38:39] offset:0 sc1
    global_load_dwordx4 v[228:231], v7, s[38:39] offset:16 sc1
    global_load_dwordx4 v[232:235], v7, s[38:39] offset:64 sc1
    global_load_dwordx4 v[236:239], v7, s[38:39] offset:80 sc1
    s_lshl_b32 s63, s40, 7
    s_add_u32 s63, s63, 0x294000
    v_mov_b32 v8, s63
    v_mov_b32 v9, 1
    s_waitcnt vmcnt(6)
    s_barrier
    s_cmp_lg_u32 s43, 0
    s_cbranch_scc1 K2_g2
    s_mov_b64 exec, 1
    global_atomic_add v8, v9, s[38:39] sc1
    s_mov_b64 exec, -1
K2_g2:
    v_lshlrev_b32 v12, 9, v6
    v_bfe_u32 v13, v0, 2, 2
    v_lshl_add_u32 v12, v13, 6, v12
    v_bfe_u32 v13, v0, 4, 1
    v_lshl_add_u32 v12, v13, 5, v12
    v_and_b32 v13, 3, v0
    v_lshl_add_u32 v12, v13, 3, v12
    s_add_u32 s63, s60, 131072
    v_add_u32 v12, s63, v12
    s_lshr_b32 s63, s8, 1
    s_lshl_b32 s63, s63, 7
    s_add_u32 s63, s63, 0x294000
    v_mov_b32 v8, s63
    s_waitcnt vmcnt(0)
    ds_read_b64_tr_b16 v[32:33], v12 offset:0
    ds_read_b64_tr_b16 v[34:35], v12 offset:256
    ds_read_b64_tr_b16 v[36:37], v12 offset:1024
    ds_read_b64_tr_b16 v[38:39], v12 offset:1280
    s_xor_b32 s66, s43, 1
    s_mul_i32 s66, s66, 12288
    s_add_u32 s66, s66, 0
    v_add_u32 v13, s66, v3
    s_xor_b32 s66, s43, 2
    s_mul_i32 s66, s66, 12288
    s_add_u32 s66, s66, 4096
    v_add_u32 v14, s66, v3
    s_xor_b32 s66, s43, 3
    s_mul_i32 s66, s66, 12288
    s_add_u32 s66, s66, 8192
    v_add_u32 v15, s66, v3
    v_and_b32 v1, 31, v0
    v_lshlrev_b32 v1, 10, v1
    v_lshl_add_u32 v1, v6, 4, v1
    s_lshl_b32 s66, s11, 15
    s_lshl_b32 s67, s10, 6
    s_add_u32 s66, s66, s67
    v_add_u32 v1, s66, v1
    s_waitcnt lgkmcnt(0)
    s_mul_i32 s66, s43, 12288
    v_add_u32 v12, s66, v3
    v_lshlrev_b32 v40, 16, v32
    v_and_b32 v41, 0xffff0000, v32
    v_lshlrev_b32 v42, 16, v33
    v_and_b32 v43, 0xffff0000, v33
    v_lshlrev_b32 v44, 16, v34
    v_and_b32 v45, 0xffff0000, v34
    v_lshlrev_b32 v46, 16, v35
    v_and_b32 v47, 0xffff0000, v35
    v_lshlrev_b32 v48, 16, v36
    v_and_b32 v49, 0xffff0000, v36
    v_lshlrev_b32 v50, 16, v37
    v_and_b32 v51, 0xffff0000, v37
    v_lshlrev_b32 v52, 16, v38
    v_and_b32 v53, 0xffff0000, v38
    v_lshlrev_b32 v54, 16, v39
    v_and_b32 v55, 0xffff0000, v39
    s_cmp_lg_u32 s43, 0
    s_cbranch_scc1 K2_go
    s_mov_b32 s66, 0
    s_mov_b64 exec, 1
K2_wait:
    global_load_dword v9, v8, s[38:39] sc1
    s_add_u32 s66, s66, 1
    s_waitcnt vmcnt(0)
    v_readfirstlane_b32 s67, v9
    s_cmp_ge_u32 s66, 0x40000
    s_cbranch_scc1 K2_go
    s_cmp_lt_u32 s67, 15
    s_cbranch_scc1 K2_wait
K2_go:
    s_mov_b64 exec, -1
    s_barrier
    buffer_load_dwordx4 v[128:131], v27, s[20:23], s13 offen sc1
    buffer_load_dwordx4 v[132:135], v28, s[20:23], s13 offen sc1
    s_add_u32 s13, s13, 4096
    buffer_load_dwordx4 v[136:139], v27, s[20:23], s13 offen sc1
    buffer_load_dwordx4 v[140:143], v28, s[20:23], s13 offen sc1
    s_add_u32 s13, s13, 4096
    buffer_load_dwordx4 v[144:147], v27, s[20:23], s13 offen sc1
    buffer_load_dwordx4 v[148:151], v28, s[20:23], s13 offen sc1
    s_add_u32 s13, s13, 4096
    buffer_load_dwordx4 v[152:155], v27, s[20:23], s13 offen sc1
    buffer_load_dwordx4 v[156:159], v28, s[20:23], s13 offen sc1
    s_add_u32 s13, s13, 4096
    buffer_load_dwordx4 v[160:163], v27, s[20:23], s13 offen sc1
    buffer_load_dwordx4 v[164:167], v28, s[20:23], s13 offen sc1
    s_add_u32 s13, s13, 4096
    buffer_load_dwordx4 v[168:171], v27, s[20:23], s13 offen sc1
    buffer_load_dwordx4 v[172:175], v28, s[20:23], s13 offen sc1
    s_add_u32 s13, s13, 4096
    s_waitcnt vmcnt(10)
    v_mfma_f32_32x32x16_bf16 v[64:79], a[0:3], v[128:131], 0
    buffer_load_dwordx4 v[176:179], v27, s[20:23], s13 offen sc1
    buffer_load_dwordx4 v[180:183], v28, s[20:23], s13 offen sc1
    s_add_u32 s13, s13, 4096
    v_mfma_f32_32x32x16_bf16 v[80:95], a[4:7], v[128:131], 0
    v_mfma_f32_32x32x16_bf16 v[96:111], a[0:3], v[132:135], 0
    v_mfma_f32_32x32x16_bf16 v[112:127], a[4:7], v[132:135], 0
    s_waitcnt vmcnt(10)
    v_mfma_f32_32x32x16_bf16 v[64:79], a[8:11], v[136:139], v[64:79]
    buffer_load_dwordx4 v[184:187], v27, s[20:23], s13 offen sc1
    buffer_load_dwordx4 v[188:191], v28, s[20:23], s13 offen sc1
    s_add_u32 s13, s13, 4096
    v_mfma_f32_32x32x16_bf16 v[80:95], a[12:15], v[136:139], v[80:95]
    v_mfma_f32_32x32x16_bf16 v[96:111], a[8:11], v[140:143], v[96:111]
    v_mfma_f32_32x32x16_bf16 v[112:127], a[12:15], v[140:143], v[112:127]
    s_waitcnt vmcnt(10)
    v_mfma_f32_32x32x16_bf16 v[64:79], a[16:19], v[144:147], v[64:79]
    buffer_load_dwordx4 v[192:195], v27, s[20:23], s13 offen sc1
    buffer_load_dwordx4 v[196:199], v28, s[20:23], s13 offen sc1
    s_add_u32 s13, s13, 4096
    v_mfma_f32_32x32x16_bf16 v[80:95], a[20:23], v[144:147], v[80:95]
    v_mfma_f32_32x32x16_bf16 v[96:111], a[16:19], v[148:151], v[96:111]
    v_mfma_f32_32x32x16_bf16 v[112:127], a[20:23], v[148:151], v[112:127]
    s_waitcnt vmcnt(10)
    v_mfma_f32_32x32x16_bf16 v[64:79], a[24:27], v[152:155], v[64:79]
    buffer_load_dwordx4 v[200:203], v27, s[20:23], s13 offen sc1
    buffer_load_dwordx4 v[204:207], v28, s[20:23], s13 offen sc1
    s_add_u32 s13, s13, 4096
    v_mfma_f32_32x32x16_bf16 v[80:95], a[28:31], v[152:155], v[80:95]
    v_mfma_f32_32x32x16_bf16 v[96:111], a[24:27], v[156:159], v[96:111]
    v_mfma_f32_32x32x16_bf16 v[112:127], a[28:31], v[156:159], v[112:127]
    s_waitcnt vmcnt(10)
    v_mfma_f32_32x32x16_bf16 v[64:79], a[32:35], v[160:163], v[64:79]
    buffer_load_dwordx4 v[208:211], v27, s[20:23], s13 offen sc1
    buffer_load_dwordx4 v[212:215], v28, s[20:23], s13 offen sc1
    s_add_u32 s13, s13, 4096
    v_mfma_f32_32x32x16_bf16 v[80:95], a[36:39], v[160:163], v[80:95]
    v_mfma_f32_32x32x16_bf16 v[96:111], a[32:35], v[164:167], v[96:111]
    v_mfma_f32_32x32x16_bf16 v[112:127], a[36:39], v[164:167], v[112:127]
    s_waitcnt vmcnt(10)
    v_mfma_f32_32x32x16_bf16 v[64:79], a[40:43], v[168:171], v[64:79]
    buffer_load_dwordx4 v[216:219], v27, s[20:23], s13 offen sc1
    buffer_load_dwordx4 v[220:223], v28, s[20:23], s13 offen sc1
    s_add_u32 s13, s13, 4096
    v_mfma_f32_32x32x16_bf16 v[80:95], a[44:47], v[168:171], v[80:95]
    v_mfma_f32_32x32x16_bf16 v[96:111], a[40:43], v[172:175], v[96:111]
    v_mfma_f32_32x32x16_bf16 v[112:127], a[44:47], v[172:175], v[112:127]
    s_waitcnt vmcnt(10)
    v_mfma_f32_32x32x16_bf16 v[64:79], a[48:51], v[176:179], v[64:79]
    buffer_load_dwordx4 a[176:179], v27, s[20:23], s13 offen sc1
    buffer_load_dwordx4 a[180:183], v28, s[20:23], s13 offen sc1
    s_add_u32 s13, s13, 4096
    v_mfma_f32_32x32x16_bf16 v[80:95], a[52:55], v[176:179], v[80:95]
    v_mfma_f32_32x32x16_bf16 v[96:111], a[48:51], v[180:183], v[96:111]
    v_mfma_f32_32x32x16_bf16 v[112:127], a[52:55], v[180:183], v[112:127]
    s_waitcnt vmcnt(10)
    v_mfma_f32_32x32x16_bf16 v[64:79], a[56:59], v[184:187], v[64:79]
    buffer_load_dwordx4 a[184:187], v27, s[20:23], s13 offen sc1
    buffer_load_dwordx4 a[188:191], v28, s[20:23], s13 offen sc1
    s_add_u32 s13, s13, 4096
    v_mfma_f32_32x32x16_bf16 v[80:95], a[60:63], v[184:187], v[80:95]
    v_mfma_f32_32x32x16_bf16 v[96:111], a[56:59], v[188:191], v[96:111]
    v_mfma_f32_32x32x16_bf16 v[112:127], a[60:63], v[188:191], v[112:127]
    s_waitcnt vmcnt(10)
    v_mfma_f32_32x32x16_bf16 v[64:79], a[64:67], v[192:195], v[64:79]
    buffer_load_dwordx4 a[192:195], v27, s[20:23], s13 offen sc1
    buffer_load_dwordx4 a[196:199], v28, s[20:23], s13 offen sc1
    s_add_u32 s13, s13, 4096
    v_mfma_f32_32x32x16_bf16 v[80:95], a[68:71], v[192:195], v[80:95]
    v_mfma_f32_32x32x16_bf16 v[96:111], a[64:67], v[196:199], v[96:111]
    v_mfma_f32_32x32x16_bf16 v[112:127], a[68:71], v[196:199], v[112:127]
    s_waitcnt vmcnt(10)
    v_mfma_f32_32x32x16_bf16 v[64:79], a[72:75], v[200:203], v[64:79]
    buffer_load_dwordx4 a[200:203], v27, s[20:23], s13 offen sc1
    buffer_load_dwordx4 a[204:207], v28, s[20:23], s13 offen sc1
    s_add_u32 s13, s13, 4096
    v_mfma_f32_32x32x16_bf16 v[80:95], a[76:79], v[200:203], v[80:95]
    v_mfma_f32_32x32x16_bf16 v[96:111], a[72:75], v[204:207], v[96:111]
    v_mfma_f32_32x32x16_bf16 v[112:127], a[76:79], v[204:207], v[112:127]
    s_waitcnt vmcnt(10)
    v_mfma_f32_32x32x16_bf16 v[64:79], a[80:83], v[208:211], v[64:79]
    buffer_load_dwordx4 a[208:211], v27, s[20:23], s13 offen sc1
    buffer_load_dwordx4 a[212:215], v28, s[20:23], s13 offen sc1
    s_add_u32 s13, s13, 4096
    v_mfma_f32_32x32x16_bf16 v[80:95], a[84:87], v[208:211], v[80:95]
    v_mfma_f32_32x32x16_bf16 v[96:111], a[80:83], v[212:215], v[96:111]
    v_mfma_f32_32x32x16_bf16 v[112:127], a[84:87], v[212:215], v[112:127]
    s_waitcnt vmcnt(10)
    v_mfma_f32_32x32x16_bf16 v[64:79], a[88:91], v[216:219], v[64:79]
    buffer_load_dwordx4 a[216:219], v27, s[20:23], s13 offen sc1
    buffer_load_dwordx4 a[220:223], v28, s[20:23], s13 offen sc1
    s_add_u32 s13, s13, 4096
    v_mfma_f32_32x32x16_bf16 v[80:95], a[92:95], v[216:219], v[80:95]
    v_mfma_f32_32x32x16_bf16 v[96:111], a[88:91], v[220:223], v[96:111]
    v_mfma_f32_32x32x16_bf16 v[112:127], a[92:95], v[220:223], v[112:127]
    s_waitcnt vmcnt(10)
    v_mfma_f32_32x32x16_bf16 v[64:79], a[96:99], a[176:179], v[64:79]
    buffer_load_dwordx4 a[224:227], v27, s[20:23], s13 offen sc1
    buffer_load_dwordx4 a[228:231], v28, s[20:23], s13 offen sc1
    s_add_u32 s13, s13, 4096
    v_mfma_f32_32x32x16_bf16 v[80:95], a[100:103], a[176:179], v[80:95]
    v_mfma_f32_32x32x16_bf16 v[96:111], a[96:99], a[180:183], v[96:111]
    v_mfma_f32_32x32x16_bf16 v[112:127], a[100:103], a[180:183], v[112:127]
    s_waitcnt vmcnt(10)
    v_mfma_f32_32x32x16_bf16 v[64:79], a[104:107], a[184:187], v[64:79]
    buffer_load_dwordx4 a[232:235], v27, s[20:23], s13 offen sc1
    buffer_load_dwordx4 a[236:239], v28, s[20:23], s13 offen sc1
    s_add_u32 s13, s13, 4096
    v_mfma_f32_32x32x16_bf16 v[80:95], a[108:111], a[184:187], v[80:95]
    v_mfma_f32_32x32x16_bf16 v[96:111], a[104:107], a[188:191], v[96:111]
    v_mfma_f32_32x32x16_bf16 v[112:127], a[108:111], a[188:191], v[112:127]
    s_waitcnt vmcnt(10)
    v_mfma_f32_32x32x16_bf16 v[64:79], a[112:115], a[192:195], v[64:79]
    buffer_load_dwordx4 a[240:243], v27, s[20:23], s13 offen sc1
    buffer_load_dwordx4 a[244:247], v28, s[20:23], s13 offen sc1
    s_add_u32 s13, s13, 4096
    v_mfma_f32_32x32x16_bf16 v[80:95], a[116:119], a[192:195], v[80:95]
    v_mfma_f32_32x32x16_bf16 v[96:111], a[112:115], a[196:199], v[96:111]
    v_mfma_f32_32x32x16_bf16 v[112:127], a[116:119], a[196:199], v[112:127]
    s_waitcnt vmcnt(10)
    v_mfma_f32_32x32x16_bf16 v[64:79], a[120:123], a[200:203], v[64:79]
    buffer_load_dwordx4 a[248:251], v27, s[20:23], s24 offen sc1
    buffer_load_dwordx4 a[252:255], v28, s[20:23], s24 offen sc1
    s_add_u32 s13, s13, 4096
    v_mfma_f32_32x32x16_bf16 v[80:95], a[124:127], a[200:203], v[80:95]
    v_mfma_f32_32x32x16_bf16 v[96:111], a[120:123], a[204:207], v[96:111]
    v_mfma_f32_32x32x16_bf16 v[112:127], a[124:127], a[204:207], v[112:127]
    s_waitcnt vmcnt(10)
    v_mfma_f32_32x32x16_bf16 v[64:79], a[128:131], a[208:211], v[64:79]
    v_mfma_f32_32x32x16_bf16 v[80:95], a[132:135], a[208:211], v[80:95]
    v_mfma_f32_32x32x16_bf16 v[96:111], a[128:131], a[212:215], v[96:111]
    v_mfma_f32_32x32x16_bf16 v[112:127], a[132:135], a[212:215], v[112:127]
    s_waitcnt vmcnt(8)
    v_mfma_f32_32x32x16_bf16 v[64:79], a[136:139], a[216:219], v[64:79]
    v_mfma_f32_32x32x16_bf16 v[80:95], a[140:143], a[216:219], v[80:95]
    v_mfma_f32_32x32x16_bf16 v[96:111], a[136:139], a[220:223], v[96:111]
    v_mfma_f32_32x32x16_bf16 v[112:127], a[140:143], a[220:223], v[112:127]
    s_waitcnt vmcnt(6)
    v_mfma_f32_32x32x16_bf16 v[64:79], a[144:147], a[224:227], v[64:79]
    v_mfma_f32_32x32x16_bf16 v[80:95], a[148:151], a[224:227], v[80:95]
    v_mfma_f32_32x32x16_bf16 v[96:111], a[144:147], a[228:231], v[96:111]
    v_mfma_f32_32x32x16_bf16 v[112:127], a[148:151], a[228:231], v[112:127]
    s_waitcnt vmcnt(4)
    v_mfma_f32_32x32x16_bf16 v[64:79], a[152:155], a[232:235], v[64:79]
    v_mfma_f32_32x32x16_bf16 v[80:95], a[156:159], a[232:235], v[80:95]
    v_mfma_f32_32x32x16_bf16 v[96:111], a[152:155], a[236:239], v[96:111]
    v_mfma_f32_32x32x16_bf16 v[112:127], a[156:159], a[236:239], v[112:127]
    s_waitcnt vmcnt(2)
    v_mfma_f32_32x32x16_bf16 v[64:79], a[160:163], a[240:243], v[64:79]
    v_mfma_f32_32x32x16_bf16 v[80:95], a[164:167], a[240:243], v[80:95]
    v_mfma_f32_32x32x16_bf16 v[96:111], a[160:163], a[244:247], v[96:111]
    v_mfma_f32_32x32x16_bf16 v[112:127], a[164:167], a[244:247], v[112:127]
    s_waitcnt vmcnt(0)
    v_mfma_f32_32x32x16_bf16 v[64:79], a[168:171], a[248:251], v[64:79]
    v_mfma_f32_32x32x16_bf16 v[80:95], a[172:175], a[248:251], v[80:95]
    v_mfma_f32_32x32x16_bf16 v[96:111], a[168:171], a[252:255], v[96:111]
    v_mfma_f32_32x32x16_bf16 v[112:127], a[172:175], a[252:255], v[112:127]
    s_nop 9
    ds_write_b128 v13, v[80:83] offset:0
    ds_write_b128 v13, v[84:87] offset:1024
    ds_write_b128 v13, v[88:91] offset:2048
    ds_write_b128 v13, v[92:95] offset:3072
    ds_write_b128 v14, v[96:99] offset:0
    ds_write_b128 v14, v[100:103] offset:1024
    ds_write_b128 v14, v[104:107] offset:2048
    ds_write_b128 v14, v[108:111] offset:3072
    ds_write_b128 v15, v[112:115] offset:0
    ds_write_b128 v15, v[116:119] offset:1024
    ds_write_b128 v15, v[120:123] offset:2048
    ds_write_b128 v15, v[124:127] offset:3072
    s_waitcnt lgkmcnt(0)
    s_barrier
    ds_read_b128 v[80:83], v12 offset:0
    ds_read_b128 v[84:87], v12 offset:1024
    ds_read_b128 v[88:91], v12 offset:2048
    ds_read_b128 v[92:95], v12 offset:3072
    ds_read_b128 v[96:99], v12 offset:4096
    ds_read_b128 v[100:103], v12 offset:5120
    ds_read_b128 v[104:107], v12 offset:6144
    ds_read_b128 v[108:111], v12 offset:7168
    ds_read_b128 v[112:115], v12 offset:8192
    ds_read_b128 v[116:119], v12 offset:9216
    ds_read_b128 v[120:123], v12 offset:10240
    ds_read_b128 v[124:127], v12 offset:11264
    s_waitcnt lgkmcnt(8)
    v_pk_add_f32 v[64:65], v[64:65], v[80:81]
    v_pk_add_f32 v[66:67], v[66:67], v[82:83]
    v_pk_add_f32 v[68:69], v[68:69], v[84:85]
    v_pk_add_f32 v[70:71], v[70:71], v[86:87]
    v_pk_add_f32 v[72:73], v[72:73], v[88:89]
    v_pk_add_f32 v[74:75], v[74:75], v[90:91]
    v_pk_add_f32 v[76:77], v[76:77], v[92:93]
    v_pk_add_f32 v[78:79], v[78:79], v[94:95]
    s_waitcnt lgkmcnt(4)
    v_pk_add_f32 v[64:65], v[64:65], v[96:97]
    v_pk_add_f32 v[66:67], v[66:67], v[98:99]
    v_pk_add_f32 v[68:69], v[68:69], v[100:101]
    v_pk_add_f32 v[70:71], v[70:71], v[102:103]
    v_pk_add_f32 v[72:73], v[72:73], v[104:105]
    v_pk_add_f32 v[74:75], v[74:75], v[106:107]
    v_pk_add_f32 v[76:77], v[76:77], v[108:109]
    v_pk_add_f32 v[78:79], v[78:79], v[110:111]
    s_waitcnt lgkmcnt(0)
    v_pk_add_f32 v[64:65], v[64:65], v[112:113]
    v_pk_add_f32 v[66:67], v[66:67], v[114:115]
    v_pk_add_f32 v[68:69], v[68:69], v[116:117]
    v_pk_add_f32 v[70:71], v[70:71], v[118:119]
    v_pk_add_f32 v[72:73], v[72:73], v[120:121]
    v_pk_add_f32 v[74:75], v[74:75], v[122:123]
    v_pk_add_f32 v[76:77], v[76:77], v[124:125]
    v_pk_add_f32 v[78:79], v[78:79], v[126:127]
    v_fmac_f32 v40, v64, v224
    v_fmac_f32 v41, v72, v225
    v_fmac_f32 v42, v65, v226
    v_fmac_f32 v43, v73, v227
    v_fmac_f32 v44, v66, v228
    v_fmac_f32 v45, v74, v229
    v_fmac_f32 v46, v67, v230
    v_fmac_f32 v47, v75, v231
    v_fmac_f32 v48, v68, v232
    v_fmac_f32 v49, v76, v233
    v_fmac_f32 v50, v69, v234
    v_fmac_f32 v51, v77, v235
    v_fmac_f32 v52, v70, v236
    v_fmac_f32 v53, v78, v237
    v_fmac_f32 v54, v71, v238
    v_fmac_f32 v55, v79, v239
    v_cvt_pk_bf16_f32 v32, v40, v41
    v_cvt_pk_bf16_f32 v33, v42, v43
    v_cvt_pk_bf16_f32 v34, v44, v45
    v_cvt_pk_bf16_f32 v35, v46, v47
    v_cvt_pk_bf16_f32 v36, v48, v49
    v_cvt_pk_bf16_f32 v37, v50, v51
    v_cvt_pk_bf16_f32 v38, v52, v53
    v_cvt_pk_bf16_f32 v39, v54, v55
    global_store_dwordx4 v1, v[32:35], s[34:35] offset:0
    global_store_dwordx4 v1, v[36:39], s[34:35] offset:32
    s_endpgm
K2_stat:
    s_add_u32 m0, s60, 0
    s_mov_b32 s61, 0
    buffer_load_dwordx4 v8, s[48:51], s61 offen sc1 lds
    buffer_load_dwordx4 v9, s[48:51], s61 offen offset:1024 sc1 lds
    s_add_u32 m0, s60, 8192
    s_mov_b32 s61, 4096
    buffer_load_dwordx4 v8, s[48:51], s61 offen sc1 lds
    buffer_load_dwordx4 v9, s[48:51], s61 offen offset:1024 sc1 lds
    s_add_u32 m0, s60, 16384
    s_mov_b32 s61, 8192
    buffer_load_dwordx4 v8, s[48:51], s61 offen sc1 lds
    buffer_load_dwordx4 v9, s[48:51], s61 offen offset:1024 sc1 lds
    s_add_u32 m0, s60, 24576
    s_mov_b32 s61, 12288
    buffer_load_dwordx4 v8, s[48:51], s61 offen sc1 lds
    buffer_load_dwordx4 v9, s[48:51], s61 offen offset:1024 sc1 lds
    s_add_u32 m0, s60, 32768
    s_mov_b32 s61, 16384
    buffer_load_dwordx4 v8, s[48:51], s61 offen sc1 lds
    buffer_load_dwordx4 v9, s[48:51], s61 offen offset:1024 sc1 lds
    s_add_u32 m0, s60, 40960
    s_mov_b32 s61, 20480
    buffer_load_dwordx4 v8, s[48:51], s61 offen sc1 lds
    buffer_load_dwordx4 v9, s[48:51], s61 offen offset:1024 sc1 lds
    s_add_u32 m0, s60, 49152
    s_mov_b32 s61, 24576
    buffer_load_dwordx4 v8, s[48:51], s61 offen sc1 lds
    buffer_load_dwordx4 v9, s[48:51], s61 offen offset:1024 sc1 lds
    s_add_u32 m0, s60, 57344
    s_mov_b32 s61, 28672
    buffer_load_dwordx4 v8, s[48:51], s61 offen sc1 lds
    buffer_load_dwordx4 v9, s[48:51], s61 offen offset:1024 sc1 lds
    s_add_u32 m0, s60, 65536
    s_mov_b32 s61, 32768
    buffer_load_dwordx4 v8, s[48:51], s61 offen sc1 lds
    buffer_load_dwordx4 v9, s[48:51], s61 offen offset:1024 sc1 lds
    s_add_u32 m0, s60, 73728
    s_mov_b32 s61, 36864
    buffer_load_dwordx4 v8, s[48:51], s61 offen sc1 lds
    buffer_load_dwordx4 v9, s[48:51], s61 offen offset:1024 sc1 lds
    s_add_u32 m0, s60, 81920
    s_mov_b32 s61, 40960
    buffer_load_dwordx4 v8, s[48:51], s61 offen sc1 lds
    buffer_load_dwordx4 v9, s[48:51], s61 offen offset:1024 sc1 lds
    s_add_u32 m0, s60, 90112
    s_mov_b32 s61, 45056
    buffer_load_dwordx4 v8, s[48:51], s61 offen sc1 lds
    buffer_load_dwordx4 v9, s[48:51], s61 offen offset:1024 sc1 lds
    s_add_u32 m0, s60, 98304
    s_mov_b32 s61, 49152
    buffer_load_dwordx4 v8, s[48:51], s61 offen sc1 lds
    buffer_load_dwordx4 v9, s[48:51], s61 offen offset:1024 sc1 lds
    s_add_u32 m0, s60, 106496
    s_mov_b32 s61, 53248
    buffer_load_dwordx4 v8, s[48:51], s61 offen sc1 lds
    buffer_load_dwordx4 v9, s[48:51], s61 offen offset:1024 sc1 lds
    s_add_u32 m0, s60, 114688
    s_mov_b32 s61, 57344
    buffer_load_dwordx4 v8, s[48:51], s61 offen sc1 lds
    buffer_load_dwordx4 v9, s[48:51], s61 offen offset:1024 sc1 lds
    s_add_u32 m0, s60, 122880
    s_mov_b32 s61, 61440
    buffer_load_dwordx4 v8, s[48:51], s61 offen sc1 lds
    buffer_load_dwordx4 v9, s[48:51], s61 offen offset:1024 sc1 lds
    v_and_b32 v7, 0x800, v6
    v_xor_b32 v6, v6, v7
    v_lshl_add_u32 v6, v7, 2, v6
    v_add_u32 v6, s60, v6
    v_xor_b32 v16, 0, v6
    v_xor_b32 v17, 32, v6
    v_xor_b32 v18, 64, v6
    v_xor_b32 v19, 96, v6
    v_mov_b32 v24, 0x3f803f80
    v_mov_b32 v25, 0x3f803f80
    v_mov_b32 v26, 0x3f803f80
    v_mov_b32 v27, 0x3f803f80
    s_waitcnt vmcnt(28)
    ds_read_b64_tr_b16 v[32:33], v16 offset:0
    ds_read_b64_tr_b16 v[34:35], v16 offset:512
    ds_read_b64_tr_b16 v[36:37], v17 offset:0
    ds_read_b64_tr_b16 v[38:39], v17 offset:512
    ds_read_b64_tr_b16 v[40:41], v18 offset:0
    ds_read_b64_tr_b16 v[42:43], v18 offset:512
    ds_read_b64_tr_b16 v[44:45], v19 offset:0
    ds_read_b64_tr_b16 v[46:47], v19 offset:512
    s_waitcnt vmcnt(24)
    ds_read_b64_tr_b16 v[48:49], v16 offset:16384
    ds_read_b64_tr_b16 v[50:51], v16 offset:16896
    ds_read_b64_tr_b16 v[52:53], v17 offset:16384
    ds_read_b64_tr_b16 v[54:55], v17 offset:16896
    ds_read_b64_tr_b16 v[56:57], v18 offset:16384
    ds_read_b64_tr_b16 v[58:59], v18 offset:16896
    ds_read_b64_tr_b16 v[60:61], v19 offset:16384
    ds_read_b64_tr_b16 v[62:63], v19 offset:16896
    s_waitcnt lgkmcnt(8)
    v_mfma_f32_16x16x32_bf16 v[64:67], v[24:27], v[32:35], 0
    v_mfma_f32_16x16x32_bf16 v[68:71], v[32:35], v[32:35], 0
    v_mfma_f32_16x16x32_bf16 v[72:75], v[24:27], v[36:39], 0
    v_mfma_f32_16x16x32_bf16 v[76:79], v[36:39], v[36:39], 0
    v_mfma_f32_16x16x32_bf16 v[80:83], v[24:27], v[40:43], 0
    v_mfma_f32_16x16x32_bf16 v[84:87], v[40:43], v[40:43], 0
    v_mfma_f32_16x16x32_bf16 v[88:91], v[24:27], v[44:47], 0
    v_mfma_f32_16x16x32_bf16 v[92:95], v[44:47], v[44:47], 0
    s_waitcnt vmcnt(20)
    ds_read_b64_tr_b16 v[32:33], v16 offset:32768
    ds_read_b64_tr_b16 v[34:35], v16 offset:33280
    ds_read_b64_tr_b16 v[36:37], v17 offset:32768
    ds_read_b64_tr_b16 v[38:39], v17 offset:33280
    ds_read_b64_tr_b16 v[40:41], v18 offset:32768
    ds_read_b64_tr_b16 v[42:43], v18 offset:33280
    ds_read_b64_tr_b16 v[44:45], v19 offset:32768
    ds_read_b64_tr_b16 v[46:47], v19 offset:33280
    s_waitcnt lgkmcnt(8)
    v_mfma_f32_16x16x32_bf16 v[64:67], v[24:27], v[48:51], v[64:67]
    v_mfma_f32_16x16x32_bf16 v[68:71], v[48:51], v[48:51], v[68:71]
    v_mfma_f32_16x16x32_bf16 v[72:75], v[24:27], v[52:55], v[72:75]
    v_mfma_f32_16x16x32_bf16 v[76:79], v[52:55], v[52:55], v[76:79]
    v_mfma_f32_16x16x32_bf16 v[80:83], v[24:27], v[56:59], v[80:83]
    v_mfma_f32_16x16x32_bf16 v[84:87], v[56:59], v[56:59], v[84:87]
    v_mfma_f32_16x16x32_bf16 v[88:91], v[24:27], v[60:63], v[88:91]
    v_mfma_f32_16x16x32_bf16 v[92:95], v[60:63], v[60:63], v[92:95]
    s_waitcnt vmcnt(16)
    ds_read_b64_tr_b16 v[48:49], v16 offset:49152
    ds_read_b64_tr_b16 v[50:51], v16 offset:49664
    ds_read_b64_tr_b16 v[52:53], v17 offset:49152
    ds_read_b64_tr_b16 v[54:55], v17 offset:49664
    ds_read_b64_tr_b16 v[56:57], v18 offset:49152
    ds_read_b64_tr_b16 v[58:59], v18 offset:49664
    ds_read_b64_tr_b16 v[60:61], v19 offset:49152
    ds_read_b64_tr_b16 v[62:63], v19 offset:49664
    s_waitcnt lgkmcnt(8)
    v_mfma_f32_16x16x32_bf16 v[64:67], v[24:27], v[32:35], v[64:67]
    v_mfma_f32_16x16x32_bf16 v[68:71], v[32:35], v[32:35], v[68:71]
    v_mfma_f32_16x16x32_bf16 v[72:75], v[24:27], v[36:39], v[72:75]
    v_mfma_f32_16x16x32_bf16 v[76:79], v[36:39], v[36:39], v[76:79]
    v_mfma_f32_16x16x32_bf16 v[80:83], v[24:27], v[40:43], v[80:83]
    v_mfma_f32_16x16x32_bf16 v[84:87], v[40:43], v[40:43], v[84:87]
    v_mfma_f32_16x16x32_bf16 v[88:91], v[24:27], v[44:47], v[88:91]
    v_mfma_f32_16x16x32_bf16 v[92:95], v[44:47], v[44:47], v[92:95]
    v_add_u32 v16, 0x10000, v16
    v_add_u32 v17, 0x10000, v17
    v_add_u32 v18, 0x10000, v18
    v_add_u32 v19, 0x10000, v19
    s_waitcnt vmcnt(12)
    ds_read_b64_tr_b16 v[32:33], v16 offset:0
    ds_read_b64_tr_b16 v[34:35], v16 offset:512
    ds_read_b64_tr_b16 v[36:37], v17 offset:0
    ds_read_b64_tr_b16 v[38:39], v17 offset:512
    ds_read_b64_tr_b16 v[40:41], v18 offset:0
    ds_read_b64_tr_b16 v[42:43], v18 offset:512
    ds_read_b64_tr_b16 v[44:45], v19 offset:0
    ds_read_b64_tr_b16 v[46:47], v19 offset:512
    s_waitcnt lgkmcnt(8)
    v_mfma_f32_16x16x32_bf16 v[64:67], v[24:27], v[48:51], v[64:67]
    v_mfma_f32_16x16x32_bf16 v[68:71], v[48:51], v[48:51], v[68:71]
    v_mfma_f32_16x16x32_bf16 v[72:75], v[24:27], v[52:55], v[72:75]
    v_mfma_f32_16x16x32_bf16 v[76:79], v[52:55], v[52:55], v[76:79]
    v_mfma_f32_16x16x32_bf16 v[80:83], v[24:27], v[56:59], v[80:83]
    v_mfma_f32_16x16x32_bf16 v[84:87], v[56:59], v[56:59], v[84:87]
    v_mfma_f32_16x16x32_bf16 v[88:91], v[24:27], v[60:63], v[88:91]
    v_mfma_f32_16x16x32_bf16 v[92:95], v[60:63], v[60:63], v[92:95]
    s_waitcnt vmcnt(8)
    ds_read_b64_tr_b16 v[48:49], v16 offset:16384
    ds_read_b64_tr_b16 v[50:51], v16 offset:16896
    ds_read_b64_tr_b16 v[52:53], v17 offset:16384
    ds_read_b64_tr_b16 v[54:55], v17 offset:16896
    ds_read_b64_tr_b16 v[56:57], v18 offset:16384
    ds_read_b64_tr_b16 v[58:59], v18 offset:16896
    ds_read_b64_tr_b16 v[60:61], v19 offset:16384
    ds_read_b64_tr_b16 v[62:63], v19 offset:16896
    s_waitcnt lgkmcnt(8)
    v_mfma_f32_16x16x32_bf16 v[64:67], v[24:27], v[32:35], v[64:67]
    v_mfma_f32_16x16x32_bf16 v[68:71], v[32:35], v[32:35], v[68:71]
    v_mfma_f32_16x16x32_bf16 v[72:75], v[24:27], v[36:39], v[72:75]
    v_mfma_f32_16x16x32_bf16 v[76:79], v[36:39], v[36:39], v[76:79]
    v_mfma_f32_16x16x32_bf16 v[80:83], v[24:27], v[40:43], v[80:83]
    v_mfma_f32_16x16x32_bf16 v[84:87], v[40:43], v[40:43], v[84:87]
    v_mfma_f32_16x16x32_bf16 v[88:91], v[24:27], v[44:47], v[88:91]
    v_mfma_f32_16x16x32_bf16 v[92:95], v[44:47], v[44:47], v[92:95]
    s_waitcnt vmcnt(4)
    ds_read_b64_tr_b16 v[32:33], v16 offset:32768
    ds_read_b64_tr_b16 v[34:35], v16 offset:33280
    ds_read_b64_tr_b16 v[36:37], v17 offset:32768
    ds_read_b64_tr_b16 v[38:39], v17 offset:33280
    ds_read_b64_tr_b16 v[40:41], v18 offset:32768
    ds_read_b64_tr_b16 v[42:43], v18 offset:33280
    ds_read_b64_tr_b16 v[44:45], v19 offset:32768
    ds_read_b64_tr_b16 v[46:47], v19 offset:33280
    s_waitcnt lgkmcnt(8)
    v_mfma_f32_16x16x32_bf16 v[64:67], v[24:27], v[48:51], v[64:67]
    v_mfma_f32_16x16x32_bf16 v[68:71], v[48:51], v[48:51], v[68:71]
    v_mfma_f32_16x16x32_bf16 v[72:75], v[24:27], v[52:55], v[72:75]
    v_mfma_f32_16x16x32_bf16 v[76:79], v[52:55], v[52:55], v[76:79]
    v_mfma_f32_16x16x32_bf16 v[80:83], v[24:27], v[56:59], v[80:83]
    v_mfma_f32_16x16x32_bf16 v[84:87], v[56:59], v[56:59], v[84:87]
    v_mfma_f32_16x16x32_bf16 v[88:91], v[24:27], v[60:63], v[88:91]
    v_mfma_f32_16x16x32_bf16 v[92:95], v[60:63], v[60:63], v[92:95]
    s_waitcnt vmcnt(0)
    ds_read_b64_tr_b16 v[48:49], v16 offset:49152
    ds_read_b64_tr_b16 v[50:51], v16 offset:49664
    ds_read_b64_tr_b16 v[52:53], v17 offset:49152
    ds_read_b64_tr_b16 v[54:55], v17 offset:49664
    ds_read_b64_tr_b16 v[56:57], v18 offset:49152
    ds_read_b64_tr_b16 v[58:59], v18 offset:49664
    ds_read_b64_tr_b16 v[60:61], v19 offset:49152
    ds_read_b64_tr_b16 v[62:63], v19 offset:49664
    s_waitcnt lgkmcnt(8)
    v_mfma_f32_16x16x32_bf16 v[64:67], v[24:27], v[32:35], v[64:67]
    v_mfma_f32_16x16x32_bf16 v[68:71], v[32:35], v[32:35], v[68:71]
    v_mfma_f32_16x16x32_bf16 v[72:75], v[24:27], v[36:39], v[72:75]
    v_mfma_f32_16x16x32_bf16 v[76:79], v[36:39], v[36:39], v[76:79]
    v_mfma_f32_16x16x32_bf16 v[80:83], v[24:27], v[40:43], v[80:83]
    v_mfma_f32_16x16x32_bf16 v[84:87], v[40:43], v[40:43], v[84:87]
    v_mfma_f32_16x16x32_bf16 v[88:91], v[24:27], v[44:47], v[88:91]
    v_mfma_f32_16x16x32_bf16 v[92:95], v[44:47], v[44:47], v[92:95]
    s_waitcnt lgkmcnt(0)
    v_mfma_f32_16x16x32_bf16 v[64:67], v[24:27], v[48:51], v[64:67]
    v_mfma_f32_16x16x32_bf16 v[68:71], v[48:51], v[48:51], v[68:71]
    v_mfma_f32_16x16x32_bf16 v[72:75], v[24:27], v[52:55], v[72:75]
    v_mfma_f32_16x16x32_bf16 v[76:79], v[52:55], v[52:55], v[76:79]
    v_mfma_f32_16x16x32_bf16 v[80:83], v[24:27], v[56:59], v[80:83]
    v_mfma_f32_16x16x32_bf16 v[84:87], v[56:59], v[56:59], v[84:87]
    v_mfma_f32_16x16x32_bf16 v[88:91], v[24:27], v[60:63], v[88:91]
    v_mfma_f32_16x16x32_bf16 v[92:95], v[60:63], v[60:63], v[92:95]
    v_and_b32 v12, 3, v0
    v_cmp_eq_u32 s[62:63], 1, v12
    v_cmp_eq_u32 s[64:65], 2, v12
    v_cmp_eq_u32 s[66:67], 3, v12
    v_and_b32 v13, 15, v0
    s_lshl_b32 s61, s43, 9
    s_add_u32 s61, s61, 131072
    v_lshl_add_u32 v13, v13, 3, s61
    s_mov_b32 exec_lo, 0x00f0000f
    s_mov_b32 exec_hi, 0xf0000f00
    v_cndmask_b32 v65, v68, v69, s[62:63]
    v_cndmask_b32 v65, v65, v70, s[64:65]
    v_cndmask_b32 v65, v65, v71, s[66:67]
    ds_write_b64 v13, v[64:65] offset:0
    v_cndmask_b32 v73, v76, v77, s[62:63]
    v_cndmask_b32 v73, v73, v78, s[64:65]
    v_cndmask_b32 v73, v73, v79, s[66:67]
    ds_write_b64 v13, v[72:73] offset:128
    v_cndmask_b32 v81, v84, v85, s[62:63]
    v_cndmask_b32 v81, v81, v86, s[64:65]
    v_cndmask_b32 v81, v81, v87, s[66:67]
    ds_write_b64 v13, v[80:81] offset:256
    v_cndmask_b32 v89, v92, v93, s[62:63]
    v_cndmask_b32 v89, v89, v94, s[64:65]
    v_cndmask_b32 v89, v89, v95, s[66:67]
    ds_write_b64 v13, v[88:89] offset:384
    s_mov_b64 exec, -1
    s_lshl_b32 s61, s43, 10
    s_add_u32 s61, s61, 131072
    v_lshl_add_u32 v17, v5, 3, s61
    s_lshl_b32 s61, s40, 10
    s_add_u32 s61, s61, 0x290000
    v_lshl_add_u32 v16, v0, 3, s61
    s_waitcnt lgkmcnt(0)
    s_barrier
    s_cmp_ge_u32 s43, 2
    s_cbranch_scc1 K2_s2
    ds_read2_b64 v[20:23], v17 offset0:0 offset1:64
    s_waitcnt lgkmcnt(0)
    v_add_f32 v20, v20, v22
    v_add_f32 v21, v21, v23
    v_mul_f32 v20, 0x3b000000, v20
    v_mul_f32 v24, v20, v20
    v_mul_f32 v21, 0x3b000000, v21
    v_sub_f32 v21, v21, v24
    v_max_f32 v21, 0, v21
    v_cvt_pk_bf16_f32 v24, v20, v21
    v_lshlrev_b32 v20, 16, v24
    v_and_b32 v21, 0xffff0000, v24
    v_add_f32 v21, 0x3727c5ac, v21
    v_cvt_pk_bf16_f32 v21, v21, v21
    v_lshlrev_b32 v21, 16, v21
    v_sqrt_f32 v21, v21
    s_nop 0
    v_cvt_pk_bf16_f32 v21, v21, v21
    v_lshlrev_b32 v21, 16, v21
    v_rcp_f32 v22, v21
    s_nop 0
    v_mul_f32 v23, -v20, v22
    global_store_dwordx2 v16, v[22:23], s[38:39] sc1
K2_s2:
    s_barrier
    s_and_b32 s14, s43, 1
    s_lshr_b32 s15, s43, 1
    s_lshl_b32 s10, s9, 1
    s_add_u32 s10, s10, s14
    s_lshl_b32 s11, s8, 1
    s_add_u32 s11, s11, s15
    s_mul_i32 s14, s10, 88064
    v_add_u32 v25, s14, v3
    s_xor_b32 s14, s10, 1
    s_mul_i32 s14, s14, 88064
    v_add_u32 v26, s14, v3
    s_mul_i32 s14, s11, 88064
    v_add_u32 v27, s14, v3
    s_xor_b32 s14, s11, 1
    s_mul_i32 s14, s14, 88064
    v_add_u32 v28, s14, v3
    s_lshl_b32 s12, s43, 10
    s_mov_b32 s13, s12
    s_add_u32 s24, s12, 86016
    s_cmp_lt_u32 s43, 2
    s_cselect_b32 s24, s24, 0x10000000
    s_add_u32 s16, s38, 0xe00000
    s_addc_u32 s17, s39, 0
    s_mov_b32 s18, 0x158000
    s_mov_b32 s19, 0x20000
    s_add_u32 s20, s38, 0xf80000
    s_addc_u32 s21, s39, 0
    s_mov_b32 s22, 0x560000
    s_mov_b32 s23, 0x20000
    buffer_load_dwordx4 a[0:3], v25, s[16:19], s12 offen sc1
    buffer_load_dwordx4 a[4:7], v26, s[16:19], s12 offen sc1
    s_add_u32 s12, s12, 4096
    buffer_load_dwordx4 a[8:11], v25, s[16:19], s12 offen sc1
    buffer_load_dwordx4 a[12:15], v26, s[16:19], s12 offen sc1
    s_add_u32 s12, s12, 4096
    buffer_load_dwordx4 a[16:19], v25, s[16:19], s12 offen sc1
    buffer_load_dwordx4 a[20:23], v26, s[16:19], s12 offen sc1
    s_add_u32 s12, s12, 4096
    buffer_load_dwordx4 a[24:27], v25, s[16:19], s12 offen sc1
    buffer_load_dwordx4 a[28:31], v26, s[16:19], s12 offen sc1
    s_add_u32 s12, s12, 4096
    buffer_load_dwordx4 a[32:35], v25, s[16:19], s12 offen sc1
    buffer_load_dwordx4 a[36:39], v26, s[16:19], s12 offen sc1
    s_add_u32 s12, s12, 4096
    buffer_load_dwordx4 a[40:43], v25, s[16:19], s12 offen sc1
    buffer_load_dwordx4 a[44:47], v26, s[16:19], s12 offen sc1
    s_add_u32 s12, s12, 4096
    buffer_load_dwordx4 a[48:51], v25, s[16:19], s12 offen sc1
    buffer_load_dwordx4 a[52:55], v26, s[16:19], s12 offen sc1
    s_add_u32 s12, s12, 4096
    buffer_load_dwordx4 a[56:59], v25, s[16:19], s12 offen sc1
    buffer_load_dwordx4 a[60:63], v26, s[16:19], s12 offen sc1
    s_add_u32 s12, s12, 4096
    buffer_load_dwordx4 a[64:67], v25, s[16:19], s12 offen sc1
    buffer_load_dwordx4 a[68:71], v26, s[16:19], s12 offen sc1
    s_add_u32 s12, s12, 4096
    buffer_load_dwordx4 a[72:75], v25, s[16:19], s12 offen sc1
    buffer_load_dwordx4 a[76:79], v26, s[16:19], s12 offen sc1
    s_add_u32 s12, s12, 4096
    buffer_load_dwordx4 a[80:83], v25, s[16:19], s12 offen sc1
    buffer_load_dwordx4 a[84:87], v26, s[16:19], s12 offen sc1
    s_add_u32 s12, s12, 4096
    buffer_load_dwordx4 a[88:91], v25, s[16:19], s12 offen sc1
    buffer_load_dwordx4 a[92:95], v26, s[16:19], s12 offen sc1
    s_add_u32 s12, s12, 4096
    buffer_load_dwordx4 a[96:99], v25, s[16:19], s12 offen sc1
    buffer_load_dwordx4 a[100:103], v26, s[16:19], s12 offen sc1
    s_add_u32 s12, s12, 4096
    buffer_load_dwordx4 a[104:107], v25, s[16:19], s12 offen sc1
    buffer_load_dwordx4 a[108:111], v26, s[16:19], s12 offen sc1
    s_add_u32 s12, s12, 4096
    buffer_load_dwordx4 a[112:115], v25, s[16:19], s12 offen sc1
    buffer_load_dwordx4 a[116:119], v26, s[16:19], s12 offen sc1
    s_add_u32 s12, s12, 4096
    buffer_load_dwordx4 a[120:123], v25, s[16:19], s12 offen sc1
    buffer_load_dwordx4 a[124:127], v26, s[16:19], s12 offen sc1
    s_add_u32 s12, s12, 4096
    buffer_load_dwordx4 a[128:131], v25, s[16:19], s12 offen sc1
    buffer_load_dwordx4 a[132:135], v26, s[16:19], s12 offen sc1
    s_add_u32 s12, s12, 4096
    buffer_load_dwordx4 a[136:139], v25, s[16:19], s12 offen sc1
    buffer_load_dwordx4 a[140:143], v26, s[16:19], s12 offen sc1
    s_add_u32 s12, s12, 4096
    buffer_load_dwordx4 a[144:147], v25, s[16:19], s12 offen sc1
    buffer_load_dwordx4 a[148:151], v26, s[16:19], s12 offen sc1
    s_add_u32 s12, s12, 4096
    buffer_load_dwordx4 a[152:155], v25, s[16:19], s12 offen sc1
    buffer_load_dwordx4 a[156:159], v26, s[16:19], s12 offen sc1
    s_add_u32 s12, s12, 4096
    buffer_load_dwordx4 a[160:163], v25, s[16:19], s12 offen sc1
    buffer_load_dwordx4 a[164:167], v26, s[16:19], s12 offen sc1
    s_add_u32 s12, s12, 4096
    buffer_load_dwordx4 a[168:171], v25, s[16:19], s24 offen sc1
    buffer_load_dwordx4 a[172:175], v26, s[16:19], s24 offen sc1
    s_add_u32 s12, s12, 4096
    s_lshl_b32 s63, s8, 16
    s_lshl_b32 s64, s10, 12
    s_add_u32 s63, s63, s64
    s_lshl_b32 s64, s15, 6
    s_add_u32 s63, s63, s64
    v_bfe_u32 v6, v0, 2, 4
    v_lshlrev_b32 v6, 7, v6
    v_and_b32 v7, 3, v0
    v_lshl_add_u32 v7, v7, 4, v6
    s_add_u32 m0, s60, 131072
    s_lshl_b32 s65, s10, 7
    s_add_u32 s65, s65, 0x28a800
    buffer_load_dwordx4 v7, s[48:51], s63 offen sc1 lds
    s_add_u32 s63, s63, 1024
    buffer_load_dwordx4 v7, s[48:51], s63 offen offset:1024 sc1 lds
    v_bfe_u32 v6, v0, 5, 1
    v_lshl_add_u32 v7, v6, 5, s65
    global_load_dwordx4 v[224:227], v7, s[38:39] offset:0 sc1
    global_load_dwordx4 v[228:231], v7, s[38:39] offset:16 sc1
    global_load_dwordx4 v[232:235], v7, s[38:39] offset:64 sc1
    global_load_dwordx4 v[236:239], v7, s[38:39] offset:80 sc1
    s_branch K2_g2
K_end:
    s_endpgm
.p2align 8
.fill 4608, 4, 0xbf810000
.section .rodata,"a"
.p2align 6
.amdhsa_kernel k0_kernel
  .amdhsa_next_free_vgpr 512
  .amdhsa_next_free_sgpr 80
  .amdhsa_accum_offset 256
  .amdhsa_group_segment_fixed_size 0
  .amdhsa_kernarg_size 128
  .amdhsa_user_sgpr_count 2
  .amdhsa_user_sgpr_kernarg_segment_ptr 1
  .amdhsa_system_sgpr_workgroup_id_x 1
.end_amdhsa_kernel
```
